```python
import torch

def _softmax(x, axis=-1):
    return torch.softmax(x, dim=axis)
def _gelu(x):
    return torch.nn.functional.gelu(x, approximate="tanh")
def _silu(x):
    return torch.nn.functional.silu(x)
def _sigmoid(x):
    return torch.sigmoid(x)
def _layernorm(x, axis=-1, eps=1e-5):
    m = x.mean(dim=axis, keepdim=True)
    v = x.var(dim=axis, keepdim=True, unbiased=False)
    return (x - m) / torch.sqrt(v + eps)
def _scatter_add(tgt, idx, src, axis=0):
    return tgt.clone().index_add_(axis, idx, src)
def _segment_sum(src, seg, n):
    out = torch.zeros((n,) + src.shape[1:], dtype=src.dtype)
    return out.index_add_(0, seg, src)
def _pad(x, pw):
    flat = tuple(v for pair in reversed(pw) for v in pair)
    return torch.nn.functional.pad(x, flat)

kernel_name = 'gated_mix__mha_block_cached__swiglu_ffn__decode'

def setup_inputs():

    _w = (lambda a: (lambda t: t.to(torch.bfloat16) if t.is_floating_point() else t)(torch.as_tensor(a)))
    def _A_setup():
        B, Sq, D = 4, 1, 512
        H, Sk, Dh = 32, 8192, 128
        return {
            "x": _w((lambda *s: torch.randn(*s, dtype=torch.bfloat16) * 0.05)(B, Sq, D)),
            "k_cache": _w((lambda *s: torch.randn(*s, dtype=torch.bfloat16) * 6.4)(B, H, Sk, Dh)),
            "v_cache": _w((lambda *s: torch.randn(*s, dtype=torch.bfloat16) * 1.6)(B, H, Sk, Dh)),
            "wq": _w((lambda *s: torch.randn(*s, dtype=torch.bfloat16) * 6.4)(D, H * Dh) * (D ** -0.5)),
            "wo": _w((lambda *s: torch.randn(*s, dtype=torch.bfloat16) * 1.6)(H * Dh, D) * ((H * Dh) ** -0.5)),
        }
    _A_in = _A_setup()

    def _B_setup():
        B, S, D, F = 4, 1, 512, 1376
        return {
            "x": _w((lambda *s: torch.randn(*s, dtype=torch.bfloat16) * 0.05)(B, S, D)),
            "w_gate": _w((lambda *s: torch.randn(*s, dtype=torch.bfloat16) * 0.2)(D, F)),
            "w_up": _w((lambda *s: torch.randn(*s, dtype=torch.bfloat16) * 0.2)(D, F)),
            "w_down": _w((lambda *s: torch.randn(*s, dtype=torch.bfloat16) * 0.2)(F, D)),
        }
    _B_in = _B_setup()

    return {
        "A_x": _A_in["x"],
        "A_k_cache": _A_in["k_cache"],
        "A_v_cache": _A_in["v_cache"],
        "A_wq": _A_in["wq"],
        "A_wo": _A_in["wo"],
        "B_x": _B_in["x"],
        "B_w_gate": _B_in["w_gate"],
        "B_w_up": _B_in["w_up"],
        "B_w_down": _B_in["w_down"],
        "gate_w": _w((lambda *s: torch.randn(*s, dtype=torch.bfloat16) * 0.05)(512) * 16.0),
    }

def reference(A_x, A_k_cache, A_v_cache, A_wq, A_wo, B_x, B_w_gate, B_w_up, B_w_down, gate_w):
    def _A_ref(x, k_cache, v_cache, wq, wo):
        B, Sq, D = x.shape
        H, Dh = 32, 128
        q = (lambda x, *d: x.permute(*d))((x @ wq).reshape(B, Sq, H, Dh), 0, 2, 1, 3)
        scores = torch.einsum("bhqd,bhkd->bhqk", q, k_cache) * (Dh ** -0.5)
        p = _softmax(scores, axis=-1)
        o = torch.einsum("bhqk,bhkd->bhqd", p, v_cache)
        return (lambda x, *d: x.permute(*d))(o, 0, 2, 1, 3).reshape(B, Sq, H * Dh) @ wo

    def _B_ref(x, w_gate, w_up, w_down):
        g = _silu(x @ w_gate)
        u = x @ w_up
        return (g * u) @ w_down

    x = A_x
    g = _sigmoid((x * gate_w).sum(-1, keepdims=True))
    a = _A_ref(x, A_k_cache, A_v_cache, A_wq, A_wo)
    b = _B_ref(x, B_w_gate, B_w_up, B_w_down)
    return g * a + (1 - g) * b
```

```asm
; @launch grid=(256,1,1) block=(512,1,1) lds=159840
.amdgcn_target "amdgcn-amd-amdhsa--gfx950"
.text
.globl gated_mix__mha_block_cached__swiglu_ffn__decode_kernel
.p2align 12
.p2align 8
.type gated_mix__mha_block_cached__swiglu_ffn__decode_kernel,@function
gated_mix__mha_block_cached__swiglu_ffn__decode_kernel:
    s_cmp_ge_u32 s2, 256
    s_cbranch_scc1 L_end
    s_load_dwordx16 s[4:19], s[0:1], 0
    s_load_dwordx8 s[20:27], s[0:1], 64
    s_load_dwordx2 s[28:29], s[0:1], 96
    v_lshrrev_b32 v1, 6, v0
    v_and_b32 v0, 63, v0
    v_readfirstlane_b32 s3, v1
    s_lshr_b32 s58, s2, 6
    s_lshl_b32 s52, s58, 1
    s_add_u32 s52, s52, s2
    s_and_b32 s52, s52, 7
    s_lshl_b32 s58, s58, 3
    s_or_b32 s52, s52, s58
    s_bfe_u32 s53, s2, 0x20004
    s_bfe_u32 s54, s2, 0x10003
    s_and_b32 s55, s3, 3
    s_lshl_b32 s66, s53, 5
    s_or_b32 s66, s66, s52
    s_lshl_b32 s66, s66, 1
    s_or_b32 s66, s66, s54
    s_cmp_ge_u32 s3, 4
    s_cbranch_scc1 L_aux
    s_lshr_b32 s58, s66, 1
    s_lshl_b32 s58, s58, 21
    s_lshl_b32 s60, s55, 12
    v_lshl_add_u32 v116, v0, 4, s60
    s_lshl_b32 s59, s54, 15
    s_and_b32 s69, s55, 1
    s_lshl_b32 s69, s69, 11
    s_add_u32 s59, s59, s69
    s_lshr_b32 s69, s55, 1
    s_lshl_b32 s69, s69, 12
    s_add_u32 s59, s59, s69
    v_lshl_add_u32 v1, v0, 4, s59
    s_mov_b32 s85, 6144
    s_mov_b32 s87, 6144
    v_lshrrev_b32 v21, 4, v0
    v_and_b32 v22, 15, v0
    s_bfe_u32 s68, s2, 0x30003
    s_lshl_b32 s69, s55, 20
    s_lshl_b32 s70, s68, 17
    s_add_u32 s69, s69, s70
    s_lshl_b32 s70, s52, 8
    s_add_u32 s69, s69, s70
    v_lshl_add_u32 v112, v22, 4, s69
    v_lshl_add_u32 v112, v21, 13, v112
    s_lshl_b32 s69, s52, 17
    s_lshl_b32 s70, s68, 14
    s_add_u32 s69, s69, s70
    v_add_u32 v113, s69, v116
    s_lshr_b32 s71, s2, 3
    s_lshl_b32 s71, s71, 2
    s_add_u32 s71, s71, s55
    s_mul_i32 s69, s71, 3072
    v_lshl_add_u32 v114, v0, 4, s69
    s_lshr_b32 s69, s71, 4
    s_lshl_b32 s69, s69, 18
    s_and_b32 s70, s71, 15
    s_lshl_b32 s70, s70, 13
    s_add_u32 s69, s69, s70
    s_bfe_u32 s70, s2, 0x10002
    s_lshl_b32 s70, s70, 17
    s_add_u32 s69, s69, s70
    s_and_b32 s71, s2, 3
    s_lshl_b32 s70, s71, 8
    s_add_u32 s69, s69, s70
    v_lshl_add_u32 v115, v22, 4, s69
    v_lshl_add_u32 v115, v21, 11, v115
    s_mul_i32 s71, s71, 352256
    s_mov_b32 s42, 0x400000
    s_mov_b32 s43, 0x20000
    s_mov_b32 s68, 0x8000
    s_mov_b32 s69, 0x10000
    s_mov_b32 s70, 0x18000
    s_waitcnt lgkmcnt(0)
    s_mov_b32 s40, s10
    s_mov_b32 s41, s11
    buffer_load_dwordx4 v[36:39], v112, s[40:43], 0 offen offset:0
    buffer_load_dwordx4 v[36:39], v112, s[40:43], s68 offen offset:0
    buffer_load_dwordx4 v[36:39], v112, s[40:43], s69 offen offset:0
    buffer_load_dwordx4 v[36:39], v112, s[40:43], s70 offen offset:0
    s_mov_b32 s40, s12
    s_mov_b32 s41, s13
    buffer_load_dwordx4 v[36:39], v113, s[40:43], 0 offen offset:0
    s_add_u32 s32, s6, s58
    s_addc_u32 s33, s7, 0
    s_mov_b32 s34, 4194304
    s_mov_b32 s35, 0x20000
    s_add_u32 s36, s8, s58
    s_addc_u32 s37, s9, 0
    s_mov_b32 s68, s71
    s_sub_u32 s36, s36, 0x200000
    s_subb_u32 s37, s37, 0
    s_lshl_b32 s58, s53, 8
    s_add_u32 s58, s58, 0x180000
    s_load_dword s67, s[28:29], s58
    v_and_b32 v21, 1, v0
    v_lshlrev_b32 v21, 4, v21
    v_mov_b32 v22, 0xffff
    v_lshlrev_b32 v22, v21, v22
    v_bfe_u32 v21, v0, 1, 3
    v_cmp_eq_u32 vcc, 0, v21
    s_nop 1
    v_cndmask_b32 v2, 0, v22, vcc
    v_cmp_eq_u32 vcc, 1, v21
    s_nop 1
    v_cndmask_b32 v3, 0, v22, vcc
    v_cmp_eq_u32 vcc, 2, v21
    s_nop 1
    v_cndmask_b32 v4, 0, v22, vcc
    v_cmp_eq_u32 vcc, 3, v21
    s_nop 1
    v_cndmask_b32 v5, 0, v22, vcc
    v_lshrrev_b32 v21, 4, v0
    v_lshlrev_b32 v21, 8, v21
    v_and_b32 v22, 15, v0
    v_lshl_add_u32 v100, v22, 2, v21
    v_mov_b32 v10, 0xff7fffff
    v_mov_b32 v11, 0
    v_mov_b32 v24, 0
    v_mov_b32 v25, 0
    v_mov_b32 v26, 0
    v_mov_b32 v27, 0
    s_mov_b32 s61, 0x3fb8aa3b
    s_mov_b32 s62, 0x3db504f3
    v_bfe_u32 v21, v0, 2, 1
    v_bfe_u32 v22, v0, 3, 1
    v_lshl_add_u32 v21, v21, 1, v22
    v_lshrrev_b32 v22, 4, v0
    v_mul_u32_u24 v22, 1088, v22
    v_lshl_add_u32 v21, v21, 2, v22
    s_mul_i32 s59, s55, 4352
    s_add_u32 s59, s59, 139264
    v_add_u32 v103, s59, v21
    s_and_b32 s88, s2, 7
    s_lshl_b32 s88, s88, 3
    s_lshr_b32 s89, s2, 6
    s_lshl_b32 s89, s89, 1
    s_add_u32 s88, s88, s89
    s_add_u32 s88, s88, s54
    s_lshl_b32 s89, s53, 6
    s_add_u32 s88, s88, s89
    s_waitcnt vmcnt(4)
    buffer_load_dwordx4 v[36:39], v113, s[40:43], 0 offen offset:1024
    s_waitcnt vmcnt(4)
    buffer_load_dwordx4 v[36:39], v113, s[40:43], 0 offen offset:2048
    s_waitcnt vmcnt(4)
    buffer_load_dwordx4 v[36:39], v113, s[40:43], 0 offen offset:3072
    s_bitcmp1_b32 s2, 2
    s_cselect_b32 s40, s18, s16
    s_cselect_b32 s41, s19, s17
    s_add_u32 s40, s40, s68
    s_addc_u32 s41, s41, 0
    s_mov_b32 s42, 352256
    s_waitcnt vmcnt(4)
    buffer_load_dwordx4 v[36:39], v114, s[40:43], 0 offen offset:0
    s_waitcnt vmcnt(4)
    buffer_load_dwordx4 v[36:39], v114, s[40:43], 0 offen offset:1024
    s_waitcnt vmcnt(4)
    buffer_load_dwordx4 v[36:39], v114, s[40:43], 0 offen offset:2048
    s_mov_b32 s40, s20
    s_mov_b32 s41, s21
    s_mov_b32 s42, 1409024
    s_waitcnt vmcnt(4)
    buffer_load_dwordx4 v[36:39], v115, s[40:43], 0 offen offset:0
    s_waitcnt vmcnt(4)
    buffer_load_dwordx4 v[36:39], v115, s[40:43], 0 offen offset:1024
    s_add_u32 m0, s60, 0
    s_waitcnt vmcnt(4)
    buffer_load_dwordx4 v1, s[32:35], 0 offen offset:0 nt lds
    s_waitcnt vmcnt(4)
    buffer_load_dwordx4 v1, s[32:35], s85 offen offset:2048 nt lds
    s_waitcnt vmcnt(4)
    buffer_load_dwordx4 v1, s[32:35], 0 offen offset:1024 nt lds
    s_waitcnt vmcnt(4)
    buffer_load_dwordx4 v1, s[32:35], s87 offen offset:3072 nt lds
    v_add_u32 v1, 16384, v1
    s_add_u32 m0, s60, 16384
    s_waitcnt vmcnt(4)
    buffer_load_dwordx4 v1, s[32:35], 0 offen offset:0 nt lds
    s_waitcnt vmcnt(4)
    buffer_load_dwordx4 v1, s[32:35], s85 offen offset:2048 nt lds
    s_waitcnt vmcnt(4)
    buffer_load_dwordx4 v1, s[32:35], 0 offen offset:1024 nt lds
    s_waitcnt vmcnt(4)
    buffer_load_dwordx4 v1, s[32:35], s87 offen offset:3072 nt lds
    v_add_u32 v1, 49152, v1
    s_add_u32 m0, s60, 32768
    s_waitcnt vmcnt(4)
    buffer_load_dwordx4 v1, s[32:35], 0 offen offset:0 nt lds
    s_waitcnt vmcnt(4)
    buffer_load_dwordx4 v1, s[32:35], s85 offen offset:2048 nt lds
    s_waitcnt vmcnt(4)
    buffer_load_dwordx4 v1, s[32:35], 0 offen offset:1024 nt lds
    s_waitcnt vmcnt(4)
    buffer_load_dwordx4 v1, s[32:35], s87 offen offset:3072 nt lds
    v_add_u32 v1, 16384, v1
    s_add_u32 m0, s60, 49152
    s_waitcnt vmcnt(4)
    buffer_load_dwordx4 v1, s[32:35], 0 offen offset:0 nt lds
    s_waitcnt vmcnt(4)
    buffer_load_dwordx4 v1, s[32:35], s85 offen offset:2048 nt lds
    s_waitcnt vmcnt(4)
    buffer_load_dwordx4 v1, s[32:35], 0 offen offset:1024 nt lds
    s_waitcnt vmcnt(4)
    buffer_load_dwordx4 v1, s[32:35], s87 offen offset:3072 nt lds
    v_add_u32 v1, 49152, v1
    s_add_u32 m0, s60, 65536
    s_waitcnt vmcnt(4)
    buffer_load_dwordx4 v1, s[32:35], 0 offen offset:0 nt lds
    s_waitcnt vmcnt(4)
    buffer_load_dwordx4 v1, s[32:35], s85 offen offset:2048 nt lds
    s_waitcnt vmcnt(4)
    buffer_load_dwordx4 v1, s[32:35], 0 offen offset:1024 nt lds
    s_waitcnt vmcnt(4)
    buffer_load_dwordx4 v1, s[32:35], s87 offen offset:3072 nt lds
    v_add_u32 v1, 16384, v1
    s_add_u32 m0, s60, 81920
    s_waitcnt vmcnt(4)
    buffer_load_dwordx4 v1, s[32:35], 0 offen offset:0 nt lds
    s_waitcnt vmcnt(4)
    buffer_load_dwordx4 v1, s[32:35], s85 offen offset:2048 nt lds
    s_waitcnt vmcnt(4)
    buffer_load_dwordx4 v1, s[32:35], 0 offen offset:1024 nt lds
    s_waitcnt vmcnt(4)
    buffer_load_dwordx4 v1, s[32:35], s87 offen offset:3072 nt lds
    v_add_u32 v1, 49152, v1
    s_add_u32 m0, s60, 98304
    s_waitcnt vmcnt(4)
    buffer_load_dwordx4 v1, s[32:35], 0 offen offset:0 nt lds
    s_waitcnt vmcnt(4)
    buffer_load_dwordx4 v1, s[32:35], s85 offen offset:2048 nt lds
    s_waitcnt vmcnt(4)
    buffer_load_dwordx4 v1, s[32:35], 0 offen offset:1024 nt lds
    s_waitcnt vmcnt(4)
    buffer_load_dwordx4 v1, s[32:35], s87 offen offset:3072 nt lds
    v_add_u32 v1, 16384, v1
    s_add_u32 m0, s60, 114688
    s_waitcnt vmcnt(4)
    buffer_load_dwordx4 v1, s[32:35], 0 offen offset:0 nt lds
    s_waitcnt vmcnt(4)
    buffer_load_dwordx4 v1, s[32:35], s85 offen offset:2048 nt lds
    s_waitcnt vmcnt(4)
    buffer_load_dwordx4 v1, s[32:35], 0 offen offset:1024 nt lds
    s_waitcnt vmcnt(4)
    buffer_load_dwordx4 v1, s[32:35], s87 offen offset:3072 nt lds
    v_add_u32 v1, 49152, v1
    s_waitcnt vmcnt(4)
    buffer_load_dwordx4 v[128:131], v1, s[32:35], 0 offen offset:0 nt
    s_waitcnt vmcnt(4)
    buffer_load_dwordx4 v[132:135], v1, s[32:35], s85 offen offset:2048 nt
    s_waitcnt vmcnt(4)
    buffer_load_dwordx4 v[136:139], v1, s[32:35], 0 offen offset:1024 nt
    s_waitcnt vmcnt(4)
    buffer_load_dwordx4 v[140:143], v1, s[32:35], s87 offen offset:3072 nt
    v_add_u32 v1, 16384, v1
    s_waitcnt vmcnt(4)
    buffer_load_dwordx4 v[144:147], v1, s[32:35], 0 offen offset:0 nt
    s_waitcnt vmcnt(4)
    buffer_load_dwordx4 v[148:151], v1, s[32:35], s85 offen offset:2048 nt
    s_waitcnt vmcnt(4)
    buffer_load_dwordx4 v[152:155], v1, s[32:35], 0 offen offset:1024 nt
    s_waitcnt vmcnt(4)
    buffer_load_dwordx4 v[156:159], v1, s[32:35], s87 offen offset:3072 nt
    v_add_u32 v1, 49152, v1
    s_waitcnt vmcnt(4)
    buffer_load_dwordx4 v[160:163], v1, s[32:35], 0 offen offset:0 nt
    s_waitcnt vmcnt(4)
    buffer_load_dwordx4 v[164:167], v1, s[32:35], s85 offen offset:2048 nt
    s_waitcnt vmcnt(4)
    buffer_load_dwordx4 v[168:171], v1, s[32:35], 0 offen offset:1024 nt
    s_waitcnt vmcnt(4)
    buffer_load_dwordx4 v[172:175], v1, s[32:35], s87 offen offset:3072 nt
    v_add_u32 v1, 16384, v1
    s_waitcnt vmcnt(4)
    buffer_load_dwordx4 v[176:179], v1, s[32:35], 0 offen offset:0 nt
    s_waitcnt vmcnt(4)
    buffer_load_dwordx4 v[180:183], v1, s[32:35], s85 offen offset:2048 nt
    s_waitcnt vmcnt(4)
    buffer_load_dwordx4 v[184:187], v1, s[32:35], 0 offen offset:1024 nt
    s_waitcnt vmcnt(4)
    buffer_load_dwordx4 v[188:191], v1, s[32:35], s87 offen offset:3072 nt
    v_add_u32 v1, 49152, v1
    s_waitcnt vmcnt(4)
    buffer_load_dwordx4 v[192:195], v1, s[32:35], 0 offen offset:0 nt
    s_waitcnt vmcnt(4)
    buffer_load_dwordx4 v[196:199], v1, s[32:35], s85 offen offset:2048 nt
    s_waitcnt vmcnt(4)
    buffer_load_dwordx4 v[200:203], v1, s[32:35], 0 offen offset:1024 nt
    s_waitcnt vmcnt(4)
    buffer_load_dwordx4 v[204:207], v1, s[32:35], s87 offen offset:3072 nt
    v_add_u32 v1, 16384, v1
    s_waitcnt vmcnt(4)
    buffer_load_dwordx4 v[208:211], v1, s[32:35], 0 offen offset:0 nt
    s_waitcnt vmcnt(4)
    buffer_load_dwordx4 v[212:215], v1, s[32:35], s85 offen offset:2048 nt
    s_waitcnt vmcnt(4)
    buffer_load_dwordx4 v[216:219], v1, s[32:35], 0 offen offset:1024 nt
    s_waitcnt vmcnt(4)
    buffer_load_dwordx4 v[220:223], v1, s[32:35], s87 offen offset:3072 nt
    v_add_u32 v1, 49152, v1
    s_waitcnt vmcnt(4)
    buffer_load_dwordx4 v[36:39], v1, s[32:35], 0 offen offset:0 nt
    buffer_load_dwordx4 v[40:43], v1, s[32:35], s85 offen offset:2048 nt
    buffer_load_dwordx4 v[44:47], v1, s[32:35], 0 offen offset:1024 nt
    buffer_load_dwordx4 v[48:51], v1, s[32:35], s87 offen offset:3072 nt
    v_add_u32 v1, 16384, v1
    buffer_load_dwordx4 v[52:55], v1, s[32:35], 0 offen offset:0 nt
    s_lshl_b32 s58, s55, 8
    s_add_u32 s58, s58, 158816
    v_lshl_add_u32 v101, v0, 2, s58
    ds_write_b32 v101, v1
    s_lshl_b32 s58, s55, 3
    s_add_u32 s58, s58, 156672
    v_mov_b32 v102, s58
    v_add_u32 v103, 128, v103
    s_mov_b32 s57, 24
    s_mov_b32 s65, 15
    s_waitcnt vmcnt(29) lgkmcnt(0)
    s_barrier
    v_and_b32 v21, 15, v0
    v_lshlrev_b32 v21, 6, v21
    v_add_u32 v21, 131072, v21
    ds_read_b128 v[68:71], v21 offset:0
    ds_read_b128 v[72:75], v21 offset:16
    ds_read_b128 v[76:79], v21 offset:1024
    ds_read_b128 v[80:83], v21 offset:1040
    ds_read_b128 v[84:87], v21 offset:2048
    ds_read_b128 v[88:91], v21 offset:2064
    ds_read_b128 v[92:95], v21 offset:3072
    ds_read_b128 v[96:99], v21 offset:3088
    s_waitcnt lgkmcnt(4)
    v_add_f32 v68, v68, v76
    v_add_f32 v69, v69, v77
    v_add_f32 v70, v70, v78
    v_add_f32 v71, v71, v79
    v_add_f32 v72, v72, v80
    v_add_f32 v73, v73, v81
    v_add_f32 v74, v74, v82
    v_add_f32 v75, v75, v83
    s_waitcnt lgkmcnt(0)
    v_add_f32 v84, v84, v92
    v_add_f32 v85, v85, v93
    v_add_f32 v86, v86, v94
    v_add_f32 v87, v87, v95
    v_add_f32 v88, v88, v96
    v_add_f32 v89, v89, v97
    v_add_f32 v90, v90, v98
    v_add_f32 v91, v91, v99
    v_add_f32 v68, v68, v84
    v_add_f32 v69, v69, v85
    v_add_f32 v70, v70, v86
    v_add_f32 v71, v71, v87
    v_add_f32 v72, v72, v88
    v_add_f32 v73, v73, v89
    v_add_f32 v74, v74, v90
    v_add_f32 v75, v75, v91
    v_cvt_pk_bf16_f32 v6, v68, v69
    v_cvt_pk_bf16_f32 v7, v70, v71
    v_cvt_pk_bf16_f32 v8, v72, v73
    v_cvt_pk_bf16_f32 v9, v74, v75
    s_waitcnt vmcnt(4)
    buffer_load_dwordx4 v[56:59], v1, s[32:35], s85 offen offset:2048 nt
    v_dot2_f32_bf16 v12, v36, v6, 0
    v_dot2_f32_bf16 v12, v37, v7, v12
    v_dot2_f32_bf16 v12, v38, v8, v12
    v_dot2_f32_bf16 v12, v39, v9, v12
    s_waitcnt vmcnt(4)
    buffer_load_dwordx4 v[60:63], v1, s[32:35], 0 offen offset:1024 nt
    v_dot2_f32_bf16 v13, v40, v6, 0
    v_dot2_f32_bf16 v13, v41, v7, v13
    v_dot2_f32_bf16 v13, v42, v8, v13
    v_dot2_f32_bf16 v13, v43, v9, v13
    v_add_f32_dpp v16, v12, v12 row_ror:8 row_mask:0xf bank_mask:0x3
    s_waitcnt vmcnt(4)
    buffer_load_dwordx4 v[64:67], v1, s[32:35], s87 offen offset:3072 nt
    v_dot2_f32_bf16 v14, v44, v6, 0
    v_dot2_f32_bf16 v14, v45, v7, v14
    v_dot2_f32_bf16 v14, v46, v8, v14
    v_dot2_f32_bf16 v14, v47, v9, v14
    v_add_f32_dpp v16, v13, v13 row_ror:8 row_mask:0xf bank_mask:0xc
    v_add_u32 v1, 49152, v1
    s_add_u32 s65, s65, 1
    s_cmp_eq_u32 s65, 64
    s_cmov_b64 s[32:33], s[36:37]
    s_waitcnt vmcnt(4)
    buffer_load_dwordx4 v[36:39], v1, s[32:35], 0 offen offset:0 nt
    v_dot2_f32_bf16 v15, v48, v6, 0
    v_dot2_f32_bf16 v15, v49, v7, v15
    v_dot2_f32_bf16 v15, v50, v8, v15
    v_dot2_f32_bf16 v15, v51, v9, v15
    v_add_f32_dpp v17, v14, v14 row_ror:8 row_mask:0xf bank_mask:0x3
    v_add_f32_dpp v18, v16, v16 row_half_mirror row_mask:0xf bank_mask:0x5
    s_nop 0
    v_add_f32_dpp v17, v15, v15 row_ror:8 row_mask:0xf bank_mask:0xc
    s_nop 1
    v_add_f32_dpp v18, v17, v17 row_half_mirror row_mask:0xf bank_mask:0xa
    s_nop 1
    v_add_f32_dpp v18, v18, v18 quad_perm:[1,0,3,2] row_mask:0xf bank_mask:0xf
    s_nop 1
    v_add_f32_dpp v18, v18, v18 quad_perm:[2,3,0,1] row_mask:0xf bank_mask:0xf
    v_cvt_pk_bf16_f32 v18, 0, v18
    v_mul_f32 v18, s62, v18
    v_cvt_pk_bf16_f32 v18, 0, v18
    ds_write_b32 v103, v18 offset:96
    v_max_f32 v10, v10, v18
    v_dot2_f32_bf16 v12, v128, v6, 0
    v_dot2_f32_bf16 v12, v129, v7, v12
    v_dot2_f32_bf16 v12, v130, v8, v12
    v_dot2_f32_bf16 v12, v131, v9, v12
    v_dot2_f32_bf16 v13, v132, v6, 0
    v_dot2_f32_bf16 v13, v133, v7, v13
    v_dot2_f32_bf16 v13, v134, v8, v13
    v_dot2_f32_bf16 v13, v135, v9, v13
    v_add_f32_dpp v16, v12, v12 row_ror:8 row_mask:0xf bank_mask:0x3
    v_dot2_f32_bf16 v14, v136, v6, 0
    v_dot2_f32_bf16 v14, v137, v7, v14
    v_dot2_f32_bf16 v14, v138, v8, v14
    v_dot2_f32_bf16 v14, v139, v9, v14
    v_add_f32_dpp v16, v13, v13 row_ror:8 row_mask:0xf bank_mask:0xc
    v_dot2_f32_bf16 v15, v140, v6, 0
    v_dot2_f32_bf16 v15, v141, v7, v15
    v_dot2_f32_bf16 v15, v142, v8, v15
    v_dot2_f32_bf16 v15, v143, v9, v15
    v_add_f32_dpp v17, v14, v14 row_ror:8 row_mask:0xf bank_mask:0x3
    v_add_f32_dpp v18, v16, v16 row_half_mirror row_mask:0xf bank_mask:0x5
    s_nop 0
    v_add_f32_dpp v17, v15, v15 row_ror:8 row_mask:0xf bank_mask:0xc
    s_nop 1
    v_add_f32_dpp v18, v17, v17 row_half_mirror row_mask:0xf bank_mask:0xa
    s_nop 1
    v_add_f32_dpp v18, v18, v18 quad_perm:[1,0,3,2] row_mask:0xf bank_mask:0xf
    s_nop 1
    v_add_f32_dpp v18, v18, v18 quad_perm:[2,3,0,1] row_mask:0xf bank_mask:0xf
    v_cvt_pk_bf16_f32 v18, 0, v18
    v_mul_f32 v18, s62, v18
    v_cvt_pk_bf16_f32 v18, 0, v18
    ds_write_b32 v103, v18 offset:0
    v_max_f32 v10, v10, v18
    v_dot2_f32_bf16 v12, v144, v6, 0
    v_dot2_f32_bf16 v12, v145, v7, v12
    v_dot2_f32_bf16 v12, v146, v8, v12
    v_dot2_f32_bf16 v12, v147, v9, v12
    v_dot2_f32_bf16 v13, v148, v6, 0
    v_dot2_f32_bf16 v13, v149, v7, v13
    v_dot2_f32_bf16 v13, v150, v8, v13
    v_dot2_f32_bf16 v13, v151, v9, v13
    v_add_f32_dpp v16, v12, v12 row_ror:8 row_mask:0xf bank_mask:0x3
    v_dot2_f32_bf16 v14, v152, v6, 0
    v_dot2_f32_bf16 v14, v153, v7, v14
    v_dot2_f32_bf16 v14, v154, v8, v14
    v_dot2_f32_bf16 v14, v155, v9, v14
    v_add_f32_dpp v16, v13, v13 row_ror:8 row_mask:0xf bank_mask:0xc
    v_dot2_f32_bf16 v15, v156, v6, 0
    v_dot2_f32_bf16 v15, v157, v7, v15
    v_dot2_f32_bf16 v15, v158, v8, v15
    v_dot2_f32_bf16 v15, v159, v9, v15
    v_add_f32_dpp v17, v14, v14 row_ror:8 row_mask:0xf bank_mask:0x3
    v_add_f32_dpp v18, v16, v16 row_half_mirror row_mask:0xf bank_mask:0x5
    s_nop 0
    v_add_f32_dpp v17, v15, v15 row_ror:8 row_mask:0xf bank_mask:0xc
    s_nop 1
    v_add_f32_dpp v18, v17, v17 row_half_mirror row_mask:0xf bank_mask:0xa
    s_nop 1
    v_add_f32_dpp v18, v18, v18 quad_perm:[1,0,3,2] row_mask:0xf bank_mask:0xf
    s_nop 1
    v_add_f32_dpp v18, v18, v18 quad_perm:[2,3,0,1] row_mask:0xf bank_mask:0xf
    v_cvt_pk_bf16_f32 v18, 0, v18
    v_mul_f32 v18, s62, v18
    v_cvt_pk_bf16_f32 v18, 0, v18
    ds_write_b32 v103, v18 offset:16
    v_max_f32 v10, v10, v18
    v_dot2_f32_bf16 v12, v160, v6, 0
    v_dot2_f32_bf16 v12, v161, v7, v12
    v_dot2_f32_bf16 v12, v162, v8, v12
    v_dot2_f32_bf16 v12, v163, v9, v12
    v_dot2_f32_bf16 v13, v164, v6, 0
    v_dot2_f32_bf16 v13, v165, v7, v13
    v_dot2_f32_bf16 v13, v166, v8, v13
    v_dot2_f32_bf16 v13, v167, v9, v13
    v_add_f32_dpp v16, v12, v12 row_ror:8 row_mask:0xf bank_mask:0x3
    v_dot2_f32_bf16 v14, v168, v6, 0
    v_dot2_f32_bf16 v14, v169, v7, v14
    v_dot2_f32_bf16 v14, v170, v8, v14
    v_dot2_f32_bf16 v14, v171, v9, v14
    v_add_f32_dpp v16, v13, v13 row_ror:8 row_mask:0xf bank_mask:0xc
    v_dot2_f32_bf16 v15, v172, v6, 0
    v_dot2_f32_bf16 v15, v173, v7, v15
    v_dot2_f32_bf16 v15, v174, v8, v15
    v_dot2_f32_bf16 v15, v175, v9, v15
    v_add_f32_dpp v17, v14, v14 row_ror:8 row_mask:0xf bank_mask:0x3
    v_add_f32_dpp v18, v16, v16 row_half_mirror row_mask:0xf bank_mask:0x5
    s_nop 0
    v_add_f32_dpp v17, v15, v15 row_ror:8 row_mask:0xf bank_mask:0xc
    s_nop 1
    v_add_f32_dpp v18, v17, v17 row_half_mirror row_mask:0xf bank_mask:0xa
    s_nop 1
    v_add_f32_dpp v18, v18, v18 quad_perm:[1,0,3,2] row_mask:0xf bank_mask:0xf
    s_nop 1
    v_add_f32_dpp v18, v18, v18 quad_perm:[2,3,0,1] row_mask:0xf bank_mask:0xf
    v_cvt_pk_bf16_f32 v18, 0, v18
    v_mul_f32 v18, s62, v18
    v_cvt_pk_bf16_f32 v18, 0, v18
    ds_write_b32 v103, v18 offset:32
    v_max_f32 v10, v10, v18
    v_dot2_f32_bf16 v12, v176, v6, 0
    v_dot2_f32_bf16 v12, v177, v7, v12
    v_dot2_f32_bf16 v12, v178, v8, v12
    v_dot2_f32_bf16 v12, v179, v9, v12
    v_dot2_f32_bf16 v13, v180, v6, 0
    v_dot2_f32_bf16 v13, v181, v7, v13
    v_dot2_f32_bf16 v13, v182, v8, v13
    v_dot2_f32_bf16 v13, v183, v9, v13
    v_add_f32_dpp v16, v12, v12 row_ror:8 row_mask:0xf bank_mask:0x3
    v_dot2_f32_bf16 v14, v184, v6, 0
    v_dot2_f32_bf16 v14, v185, v7, v14
    v_dot2_f32_bf16 v14, v186, v8, v14
    v_dot2_f32_bf16 v14, v187, v9, v14
    v_add_f32_dpp v16, v13, v13 row_ror:8 row_mask:0xf bank_mask:0xc
    v_dot2_f32_bf16 v15, v188, v6, 0
    v_dot2_f32_bf16 v15, v189, v7, v15
    v_dot2_f32_bf16 v15, v190, v8, v15
    v_dot2_f32_bf16 v15, v191, v9, v15
    v_add_f32_dpp v17, v14, v14 row_ror:8 row_mask:0xf bank_mask:0x3
    v_add_f32_dpp v18, v16, v16 row_half_mirror row_mask:0xf bank_mask:0x5
    s_nop 0
    v_add_f32_dpp v17, v15, v15 row_ror:8 row_mask:0xf bank_mask:0xc
    s_nop 1
    v_add_f32_dpp v18, v17, v17 row_half_mirror row_mask:0xf bank_mask:0xa
    s_nop 1
    v_add_f32_dpp v18, v18, v18 quad_perm:[1,0,3,2] row_mask:0xf bank_mask:0xf
    s_nop 1
    v_add_f32_dpp v18, v18, v18 quad_perm:[2,3,0,1] row_mask:0xf bank_mask:0xf
    v_cvt_pk_bf16_f32 v18, 0, v18
    v_mul_f32 v18, s62, v18
    v_cvt_pk_bf16_f32 v18, 0, v18
    ds_write_b32 v103, v18 offset:48
    v_max_f32 v10, v10, v18
    v_dot2_f32_bf16 v12, v192, v6, 0
    v_dot2_f32_bf16 v12, v193, v7, v12
    v_dot2_f32_bf16 v12, v194, v8, v12
    v_dot2_f32_bf16 v12, v195, v9, v12
    v_dot2_f32_bf16 v13, v196, v6, 0
    v_dot2_f32_bf16 v13, v197, v7, v13
    v_dot2_f32_bf16 v13, v198, v8, v13
    v_dot2_f32_bf16 v13, v199, v9, v13
    v_add_f32_dpp v16, v12, v12 row_ror:8 row_mask:0xf bank_mask:0x3
    v_dot2_f32_bf16 v14, v200, v6, 0
    v_dot2_f32_bf16 v14, v201, v7, v14
    v_dot2_f32_bf16 v14, v202, v8, v14
    v_dot2_f32_bf16 v14, v203, v9, v14
    v_add_f32_dpp v16, v13, v13 row_ror:8 row_mask:0xf bank_mask:0xc
    v_dot2_f32_bf16 v15, v204, v6, 0
    v_dot2_f32_bf16 v15, v205, v7, v15
    v_dot2_f32_bf16 v15, v206, v8, v15
    v_dot2_f32_bf16 v15, v207, v9, v15
    v_add_f32_dpp v17, v14, v14 row_ror:8 row_mask:0xf bank_mask:0x3
    v_add_f32_dpp v18, v16, v16 row_half_mirror row_mask:0xf bank_mask:0x5
    s_nop 0
    v_add_f32_dpp v17, v15, v15 row_ror:8 row_mask:0xf bank_mask:0xc
    s_nop 1
    v_add_f32_dpp v18, v17, v17 row_half_mirror row_mask:0xf bank_mask:0xa
    s_nop 1
    v_add_f32_dpp v18, v18, v18 quad_perm:[1,0,3,2] row_mask:0xf bank_mask:0xf
    s_nop 1
    v_add_f32_dpp v18, v18, v18 quad_perm:[2,3,0,1] row_mask:0xf bank_mask:0xf
    v_cvt_pk_bf16_f32 v18, 0, v18
    v_mul_f32 v18, s62, v18
    v_cvt_pk_bf16_f32 v18, 0, v18
    ds_write_b32 v103, v18 offset:64
    v_max_f32 v10, v10, v18
    v_dot2_f32_bf16 v12, v208, v6, 0
    v_dot2_f32_bf16 v12, v209, v7, v12
    v_dot2_f32_bf16 v12, v210, v8, v12
    v_dot2_f32_bf16 v12, v211, v9, v12
    v_dot2_f32_bf16 v13, v212, v6, 0
    v_dot2_f32_bf16 v13, v213, v7, v13
    v_dot2_f32_bf16 v13, v214, v8, v13
    v_dot2_f32_bf16 v13, v215, v9, v13
    v_add_f32_dpp v16, v12, v12 row_ror:8 row_mask:0xf bank_mask:0x3
    v_dot2_f32_bf16 v14, v216, v6, 0
    v_dot2_f32_bf16 v14, v217, v7, v14
    v_dot2_f32_bf16 v14, v218, v8, v14
    v_dot2_f32_bf16 v14, v219, v9, v14
    v_add_f32_dpp v16, v13, v13 row_ror:8 row_mask:0xf bank_mask:0xc
    v_dot2_f32_bf16 v15, v220, v6, 0
    v_dot2_f32_bf16 v15, v221, v7, v15
    v_dot2_f32_bf16 v15, v222, v8, v15
    v_dot2_f32_bf16 v15, v223, v9, v15
    v_add_f32_dpp v17, v14, v14 row_ror:8 row_mask:0xf bank_mask:0x3
    v_add_f32_dpp v18, v16, v16 row_half_mirror row_mask:0xf bank_mask:0x5
    s_nop 0
    v_add_f32_dpp v17, v15, v15 row_ror:8 row_mask:0xf bank_mask:0xc
    s_nop 1
    v_add_f32_dpp v18, v17, v17 row_half_mirror row_mask:0xf bank_mask:0xa
    s_nop 1
    v_add_f32_dpp v18, v18, v18 quad_perm:[1,0,3,2] row_mask:0xf bank_mask:0xf
    s_nop 1
    v_add_f32_dpp v18, v18, v18 quad_perm:[2,3,0,1] row_mask:0xf bank_mask:0xf
    v_cvt_pk_bf16_f32 v18, 0, v18
    v_mul_f32 v18, s62, v18
    v_cvt_pk_bf16_f32 v18, 0, v18
    ds_write_b32 v103, v18 offset:80
    v_max_f32 v10, v10, v18
    s_waitcnt vmcnt(4)
    buffer_load_dwordx4 v[40:43], v1, s[32:35], s85 offen offset:2048 nt
    v_dot2_f32_bf16 v12, v52, v6, 0
    v_dot2_f32_bf16 v12, v53, v7, v12
    v_dot2_f32_bf16 v12, v54, v8, v12
    v_dot2_f32_bf16 v12, v55, v9, v12
    s_waitcnt vmcnt(4)
    buffer_load_dwordx4 v[44:47], v1, s[32:35], 0 offen offset:1024 nt
    v_dot2_f32_bf16 v13, v56, v6, 0
    v_dot2_f32_bf16 v13, v57, v7, v13
    v_dot2_f32_bf16 v13, v58, v8, v13
    v_dot2_f32_bf16 v13, v59, v9, v13
    v_add_f32_dpp v16, v12, v12 row_ror:8 row_mask:0xf bank_mask:0x3
    s_waitcnt vmcnt(4)
    buffer_load_dwordx4 v[48:51], v1, s[32:35], s87 offen offset:3072 nt
    v_dot2_f32_bf16 v14, v60, v6, 0
    v_dot2_f32_bf16 v14, v61, v7, v14
    v_dot2_f32_bf16 v14, v62, v8, v14
    v_dot2_f32_bf16 v14, v63, v9, v14
    v_add_f32_dpp v16, v13, v13 row_ror:8 row_mask:0xf bank_mask:0xc
    v_add_u32 v1, 16384, v1
    s_add_u32 s65, s65, 1
    s_cmp_eq_u32 s65, 64
    s_cmov_b64 s[32:33], s[36:37]
    s_waitcnt vmcnt(4)
    buffer_load_dwordx4 v[52:55], v1, s[32:35], 0 offen offset:0 nt
    v_dot2_f32_bf16 v15, v64, v6, 0
    v_dot2_f32_bf16 v15, v65, v7, v15
    v_dot2_f32_bf16 v15, v66, v8, v15
    v_dot2_f32_bf16 v15, v67, v9, v15
    v_add_f32_dpp v17, v14, v14 row_ror:8 row_mask:0xf bank_mask:0x3
    v_add_f32_dpp v18, v16, v16 row_half_mirror row_mask:0xf bank_mask:0x5
    s_nop 0
    v_add_f32_dpp v17, v15, v15 row_ror:8 row_mask:0xf bank_mask:0xc
    s_nop 1
    v_add_f32_dpp v18, v17, v17 row_half_mirror row_mask:0xf bank_mask:0xa
    s_nop 1
    v_add_f32_dpp v18, v18, v18 quad_perm:[1,0,3,2] row_mask:0xf bank_mask:0xf
    s_nop 1
    v_add_f32_dpp v18, v18, v18 quad_perm:[2,3,0,1] row_mask:0xf bank_mask:0xf
    v_cvt_pk_bf16_f32 v18, 0, v18
    v_mul_f32 v18, s62, v18
    v_cvt_pk_bf16_f32 v18, 0, v18
    ds_write_b32 v103, v18 offset:112
    v_max_f32 v10, v10, v18
    v_add_u32 v103, 128, v103
    v_mov_b32 v111, 156760
.p2align 6
L_kloop:
    ds_read_b64 v[108:109], v102
    s_waitcnt vmcnt(4)
    buffer_load_dwordx4 v[56:59], v1, s[32:35], s85 offen offset:2048 nt
    v_dot2_f32_bf16 v12, v36, v6, 0
    v_dot2_f32_bf16 v12, v37, v7, v12
    v_dot2_f32_bf16 v12, v38, v8, v12
    v_dot2_f32_bf16 v12, v39, v9, v12
    s_waitcnt vmcnt(4)
    buffer_load_dwordx4 v[60:63], v1, s[32:35], 0 offen offset:1024 nt
    v_dot2_f32_bf16 v13, v40, v6, 0
    v_dot2_f32_bf16 v13, v41, v7, v13
    v_dot2_f32_bf16 v13, v42, v8, v13
    v_dot2_f32_bf16 v13, v43, v9, v13
    v_add_f32_dpp v16, v12, v12 row_ror:8 row_mask:0xf bank_mask:0x3
    s_waitcnt vmcnt(4)
    buffer_load_dwordx4 v[64:67], v1, s[32:35], s87 offen offset:3072 nt
    v_dot2_f32_bf16 v14, v44, v6, 0
    v_dot2_f32_bf16 v14, v45, v7, v14
    v_dot2_f32_bf16 v14, v46, v8, v14
    v_dot2_f32_bf16 v14, v47, v9, v14
    v_add_f32_dpp v16, v13, v13 row_ror:8 row_mask:0xf bank_mask:0xc
    v_add_u32 v1, 49152, v1
    s_add_u32 s65, s65, 1
    s_cmp_eq_u32 s65, 64
    s_cmov_b64 s[32:33], s[36:37]
    s_waitcnt vmcnt(4)
    buffer_load_dwordx4 v[36:39], v1, s[32:35], 0 offen offset:0 nt
    v_dot2_f32_bf16 v15, v48, v6, 0
    v_dot2_f32_bf16 v15, v49, v7, v15
    v_dot2_f32_bf16 v15, v50, v8, v15
    v_dot2_f32_bf16 v15, v51, v9, v15
    v_add_f32_dpp v17, v14, v14 row_ror:8 row_mask:0xf bank_mask:0x3
    v_add_f32_dpp v18, v16, v16 row_half_mirror row_mask:0xf bank_mask:0x5
    s_nop 0
    v_add_f32_dpp v17, v15, v15 row_ror:8 row_mask:0xf bank_mask:0xc
    s_nop 1
    v_add_f32_dpp v18, v17, v17 row_half_mirror row_mask:0xf bank_mask:0xa
    s_nop 1
    v_add_f32_dpp v18, v18, v18 quad_perm:[1,0,3,2] row_mask:0xf bank_mask:0xf
    s_nop 1
    v_add_f32_dpp v18, v18, v18 quad_perm:[2,3,0,1] row_mask:0xf bank_mask:0xf
    v_cvt_pk_bf16_f32 v18, 0, v18
    v_mul_f32 v18, s62, v18
    v_cvt_pk_bf16_f32 v18, 0, v18
    ds_write_b32 v103, v18 offset:0
    v_max_f32 v10, v10, v18
    ds_read_b32 v110, v111
    s_waitcnt vmcnt(4)
    buffer_load_dwordx4 v[40:43], v1, s[32:35], s85 offen offset:2048 nt
    v_dot2_f32_bf16 v12, v52, v6, 0
    v_dot2_f32_bf16 v12, v53, v7, v12
    v_dot2_f32_bf16 v12, v54, v8, v12
    v_dot2_f32_bf16 v12, v55, v9, v12
    s_waitcnt vmcnt(4)
    buffer_load_dwordx4 v[44:47], v1, s[32:35], 0 offen offset:1024 nt
    v_dot2_f32_bf16 v13, v56, v6, 0
    v_dot2_f32_bf16 v13, v57, v7, v13
    v_dot2_f32_bf16 v13, v58, v8, v13
    v_dot2_f32_bf16 v13, v59, v9, v13
    v_add_f32_dpp v16, v12, v12 row_ror:8 row_mask:0xf bank_mask:0x3
    s_waitcnt vmcnt(4)
    buffer_load_dwordx4 v[48:51], v1, s[32:35], s87 offen offset:3072 nt
    v_dot2_f32_bf16 v14, v60, v6, 0
    v_dot2_f32_bf16 v14, v61, v7, v14
    v_dot2_f32_bf16 v14, v62, v8, v14
    v_dot2_f32_bf16 v14, v63, v9, v14
    v_add_f32_dpp v16, v13, v13 row_ror:8 row_mask:0xf bank_mask:0xc
    v_add_u32 v1, 16384, v1
    s_add_u32 s65, s65, 1
    s_cmp_eq_u32 s65, 64
    s_cmov_b64 s[32:33], s[36:37]
    s_waitcnt vmcnt(4)
    buffer_load_dwordx4 v[52:55], v1, s[32:35], 0 offen offset:0 nt
    v_dot2_f32_bf16 v15, v64, v6, 0
    v_dot2_f32_bf16 v15, v65, v7, v15
    v_dot2_f32_bf16 v15, v66, v8, v15
    v_dot2_f32_bf16 v15, v67, v9, v15
    v_add_f32_dpp v17, v14, v14 row_ror:8 row_mask:0xf bank_mask:0x3
    v_add_f32_dpp v18, v16, v16 row_half_mirror row_mask:0xf bank_mask:0x5
    s_nop 0
    v_add_f32_dpp v17, v15, v15 row_ror:8 row_mask:0xf bank_mask:0xc
    s_nop 1
    v_add_f32_dpp v18, v17, v17 row_half_mirror row_mask:0xf bank_mask:0xa
    s_nop 1
    v_add_f32_dpp v18, v18, v18 quad_perm:[1,0,3,2] row_mask:0xf bank_mask:0xf
    s_nop 1
    v_add_f32_dpp v18, v18, v18 quad_perm:[2,3,0,1] row_mask:0xf bank_mask:0xf
    v_cvt_pk_bf16_f32 v18, 0, v18
    v_mul_f32 v18, s62, v18
    v_cvt_pk_bf16_f32 v18, 0, v18
    ds_write_b32 v103, v18 offset:16
    v_max_f32 v10, v10, v18
L_knext:
    v_add_u32 v103, 32, v103
    s_waitcnt lgkmcnt(1)
    v_readfirstlane_b32 s58, v110
    s_sub_u32 s57, s57, 1
    s_cmp_eq_u32 s57, 0
    s_cbranch_scc1 L_kend
    ds_write_b32 v101, v1
    s_cmp_le_i32 s57, s58
    s_cbranch_scc1 L_kloop
    ds_read_b64 v[108:109], v102
    s_waitcnt vmcnt(4)
    buffer_load_dwordx4 v[56:59], v1, s[32:35], s85 offen offset:2048 nt
    buffer_load_dwordx4 v[60:63], v1, s[32:35], 0 offen offset:1024 nt
    buffer_load_dwordx4 v[64:67], v1, s[32:35], s87 offen offset:3072 nt
    v_dot2_f32_bf16 v12, v36, v6, 0
    v_dot2_f32_bf16 v12, v37, v7, v12
    v_dot2_f32_bf16 v12, v38, v8, v12
    v_dot2_f32_bf16 v12, v39, v9, v12
    v_add_u32 v1, 49152, v1
    s_add_u32 s65, s65, 1
    s_cmp_eq_u32 s65, 64
    s_cmov_b64 s[32:33], s[36:37]
    s_waitcnt vmcnt(6)
    buffer_load_dwordx4 v[36:39], v1, s[32:35], 0 offen offset:0 nt
    v_dot2_f32_bf16 v13, v40, v6, 0
    v_dot2_f32_bf16 v13, v41, v7, v13
    v_dot2_f32_bf16 v13, v42, v8, v13
    v_dot2_f32_bf16 v13, v43, v9, v13
    v_add_f32_dpp v16, v12, v12 row_ror:8 row_mask:0xf bank_mask:0x3
    s_waitcnt vmcnt(6)
    buffer_load_dwordx4 v[40:43], v1, s[32:35], s85 offen offset:2048 nt
    v_dot2_f32_bf16 v14, v44, v6, 0
    v_dot2_f32_bf16 v14, v45, v7, v14
    v_dot2_f32_bf16 v14, v46, v8, v14
    v_dot2_f32_bf16 v14, v47, v9, v14
    v_add_f32_dpp v16, v13, v13 row_ror:8 row_mask:0xf bank_mask:0xc
    s_waitcnt vmcnt(6)
    buffer_load_dwordx4 v[44:47], v1, s[32:35], 0 offen offset:1024 nt
    v_dot2_f32_bf16 v15, v48, v6, 0
    v_dot2_f32_bf16 v15, v49, v7, v15
    v_dot2_f32_bf16 v15, v50, v8, v15
    v_dot2_f32_bf16 v15, v51, v9, v15
    v_add_f32_dpp v17, v14, v14 row_ror:8 row_mask:0xf bank_mask:0x3
    v_add_f32_dpp v18, v16, v16 row_half_mirror row_mask:0xf bank_mask:0x5
    s_nop 0
    v_add_f32_dpp v17, v15, v15 row_ror:8 row_mask:0xf bank_mask:0xc
    s_nop 1
    v_add_f32_dpp v18, v17, v17 row_half_mirror row_mask:0xf bank_mask:0xa
    s_nop 1
    v_add_f32_dpp v18, v18, v18 quad_perm:[1,0,3,2] row_mask:0xf bank_mask:0xf
    s_nop 1
    v_add_f32_dpp v18, v18, v18 quad_perm:[2,3,0,1] row_mask:0xf bank_mask:0xf
    v_cvt_pk_bf16_f32 v18, 0, v18
    v_mul_f32 v18, s62, v18
    v_cvt_pk_bf16_f32 v18, 0, v18
    ds_write_b32 v103, v18 offset:0
    v_max_f32 v10, v10, v18
    ds_read_b32 v110, v111
    s_waitcnt vmcnt(6)
    buffer_load_dwordx4 v[48:51], v1, s[32:35], s87 offen offset:3072 nt
    v_dot2_f32_bf16 v12, v52, v6, 0
    v_dot2_f32_bf16 v12, v53, v7, v12
    v_dot2_f32_bf16 v12, v54, v8, v12
    v_dot2_f32_bf16 v12, v55, v9, v12
    v_add_u32 v1, 16384, v1
    s_add_u32 s65, s65, 1
    s_cmp_eq_u32 s65, 64
    s_cmov_b64 s[32:33], s[36:37]
    s_waitcnt vmcnt(6)
    buffer_load_dwordx4 v[52:55], v1, s[32:35], 0 offen offset:0 nt
    v_dot2_f32_bf16 v13, v56, v6, 0
    v_dot2_f32_bf16 v13, v57, v7, v13
    v_dot2_f32_bf16 v13, v58, v8, v13
    v_dot2_f32_bf16 v13, v59, v9, v13
    v_add_f32_dpp v16, v12, v12 row_ror:8 row_mask:0xf bank_mask:0x3
    s_waitcnt vmcnt(6)
    v_dot2_f32_bf16 v14, v60, v6, 0
    v_dot2_f32_bf16 v14, v61, v7, v14
    v_dot2_f32_bf16 v14, v62, v8, v14
    v_dot2_f32_bf16 v14, v63, v9, v14
    v_add_f32_dpp v16, v13, v13 row_ror:8 row_mask:0xf bank_mask:0xc
    s_waitcnt vmcnt(5)
    v_dot2_f32_bf16 v15, v64, v6, 0
    v_dot2_f32_bf16 v15, v65, v7, v15
    v_dot2_f32_bf16 v15, v66, v8, v15
    v_dot2_f32_bf16 v15, v67, v9, v15
    v_add_f32_dpp v17, v14, v14 row_ror:8 row_mask:0xf bank_mask:0x3
    v_add_f32_dpp v18, v16, v16 row_half_mirror row_mask:0xf bank_mask:0x5
    s_nop 0
    v_add_f32_dpp v17, v15, v15 row_ror:8 row_mask:0xf bank_mask:0xc
    s_nop 1
    v_add_f32_dpp v18, v17, v17 row_half_mirror row_mask:0xf bank_mask:0xa
    s_nop 1
    v_add_f32_dpp v18, v18, v18 quad_perm:[1,0,3,2] row_mask:0xf bank_mask:0xf
    s_nop 1
    v_add_f32_dpp v18, v18, v18 quad_perm:[2,3,0,1] row_mask:0xf bank_mask:0xf
    v_cvt_pk_bf16_f32 v18, 0, v18
    v_mul_f32 v18, s62, v18
    v_cvt_pk_bf16_f32 v18, 0, v18
    ds_write_b32 v103, v18 offset:16
    v_max_f32 v10, v10, v18
    s_branch L_knext
L_kend:
    v_lshrrev_b32 v22, 4, v0
    v_mul_u32_u24 v22, 1088, v22
    v_and_b32 v21, 15, v0
    v_lshl_add_u32 v21, v21, 2, v22
    s_mul_i32 s59, s55, 4352
    s_add_u32 s59, s59, 139264
    v_add_u32 v103, s59, v21
    s_mov_b32 s57, 262144
L_zchk:
    s_waitcnt lgkmcnt(0)
    v_readfirstlane_b32 s58, v109
    s_nop 1
    s_cmp_eq_u32 s58, 1
    s_cbranch_scc1 L_zok
    ds_read_b64 v[108:109], v102
    s_sub_u32 s57, s57, 1
    s_cmp_lg_u32 s57, 0
    s_cbranch_scc1 L_zchk
L_zok:
    ds_read_b32 v19, v103
    ds_read_b32 v104, v103 offset:64
    v_max_f32 v10, v10, v108
    s_nop 1
    v_max_f32_dpp v10, v10, v10 row_ror:8 row_mask:0xf bank_mask:0xf
    s_nop 1
    v_max_f32_dpp v10, v10, v10 row_ror:4 row_mask:0xf bank_mask:0xf
    s_nop 1
    v_max_f32_dpp v10, v10, v10 row_bcast:15 row_mask:0xa bank_mask:0xf
    s_nop 1
    v_max_f32_dpp v10, v10, v10 row_bcast:31 row_mask:0xc bank_mask:0xf
    s_nop 0
    v_readlane_b32 s60, v10, 63
    s_nop 1
    v_mov_b32 v10, s60
    v_mul_f32 v10, s61, v10
    s_lshl_b32 s58, s55, 2
    s_add_u32 s58, s58, 156704
    v_mov_b32 v21, s58
    s_waitcnt lgkmcnt(1)
    v_fma_f32 v19, v19, s61, -v10
    v_exp_f32 v19, v19
    ds_write_b32 v21, v10
    v_cvt_pk_bf16_f32 v20, v19, v19
    s_mov_b32 s57, 14
    s_mov_b32 s65, 1
    v_add_u32 v103, 128, v103
    v_mov_b32 v102, 156752
    v_and_b32_dpp v28, v20, v2 row_newbcast:0 row_mask:0xf bank_mask:0xf
    v_and_b32_dpp v29, v20, v3 row_newbcast:0 row_mask:0xf bank_mask:0xf
    v_and_b32_dpp v30, v20, v4 row_newbcast:0 row_mask:0xf bank_mask:0xf
    v_and_b32_dpp v31, v20, v5 row_newbcast:0 row_mask:0xf bank_mask:0xf
.p2align 6
L_vloop:
    ds_write_b32 v101, v1
    s_waitcnt vmcnt(4)
    buffer_load_dwordx4 v[56:59], v1, s[32:35], s85 offen offset:2048 nt
    v_mfma_f32_16x16x32_bf16 v[24:27], v[36:39], v[28:31], v[24:27]
    v_and_b32_dpp v32, v20, v2 row_newbcast:1 row_mask:0xf bank_mask:0xf
    v_and_b32_dpp v33, v20, v3 row_newbcast:1 row_mask:0xf bank_mask:0xf
    v_and_b32_dpp v34, v20, v4 row_newbcast:1 row_mask:0xf bank_mask:0xf
    v_and_b32_dpp v35, v20, v5 row_newbcast:1 row_mask:0xf bank_mask:0xf
    s_waitcnt vmcnt(4)
    buffer_load_dwordx4 v[60:63], v1, s[32:35], 0 offen offset:1024 nt
    v_mfma_f32_16x16x32_bf16 v[24:27], v[40:43], v[32:35], v[24:27]
    v_and_b32_dpp v28, v20, v2 row_newbcast:2 row_mask:0xf bank_mask:0xf
    v_and_b32_dpp v29, v20, v3 row_newbcast:2 row_mask:0xf bank_mask:0xf
    v_and_b32_dpp v30, v20, v4 row_newbcast:2 row_mask:0xf bank_mask:0xf
    v_and_b32_dpp v31, v20, v5 row_newbcast:2 row_mask:0xf bank_mask:0xf
    s_waitcnt vmcnt(4)
    buffer_load_dwordx4 v[64:67], v1, s[32:35], s87 offen offset:3072 nt
    v_mfma_f32_16x16x32_bf16 v[24:27], v[44:47], v[28:31], v[24:27]
    v_and_b32_dpp v32, v20, v2 row_newbcast:3 row_mask:0xf bank_mask:0xf
    v_and_b32_dpp v33, v20, v3 row_newbcast:3 row_mask:0xf bank_mask:0xf
    v_and_b32_dpp v34, v20, v4 row_newbcast:3 row_mask:0xf bank_mask:0xf
    v_and_b32_dpp v35, v20, v5 row_newbcast:3 row_mask:0xf bank_mask:0xf
    v_add_u32 v1, 49152, v1
    s_waitcnt vmcnt(4)
    buffer_load_dwordx4 v[128:131], v1, s[32:35], 0 offen offset:0 nt
    v_mfma_f32_16x16x32_bf16 v[24:27], v[48:51], v[32:35], v[24:27]
    v_and_b32_dpp v28, v20, v2 row_newbcast:4 row_mask:0xf bank_mask:0xf
    v_and_b32_dpp v29, v20, v3 row_newbcast:4 row_mask:0xf bank_mask:0xf
    v_and_b32_dpp v30, v20, v4 row_newbcast:4 row_mask:0xf bank_mask:0xf
    v_and_b32_dpp v31, v20, v5 row_newbcast:4 row_mask:0xf bank_mask:0xf
    s_waitcnt vmcnt(4)
    buffer_load_dwordx4 v[132:135], v1, s[32:35], s85 offen offset:2048 nt
    v_mfma_f32_16x16x32_bf16 v[24:27], v[52:55], v[28:31], v[24:27]
    v_and_b32_dpp v32, v20, v2 row_newbcast:5 row_mask:0xf bank_mask:0xf
    v_and_b32_dpp v33, v20, v3 row_newbcast:5 row_mask:0xf bank_mask:0xf
    v_and_b32_dpp v34, v20, v4 row_newbcast:5 row_mask:0xf bank_mask:0xf
    v_and_b32_dpp v35, v20, v5 row_newbcast:5 row_mask:0xf bank_mask:0xf
    s_waitcnt vmcnt(4)
    buffer_load_dwordx4 v[136:139], v1, s[32:35], 0 offen offset:1024 nt
    v_mfma_f32_16x16x32_bf16 v[24:27], v[56:59], v[32:35], v[24:27]
    v_and_b32_dpp v28, v20, v2 row_newbcast:6 row_mask:0xf bank_mask:0xf
    v_and_b32_dpp v29, v20, v3 row_newbcast:6 row_mask:0xf bank_mask:0xf
    v_and_b32_dpp v30, v20, v4 row_newbcast:6 row_mask:0xf bank_mask:0xf
    v_and_b32_dpp v31, v20, v5 row_newbcast:6 row_mask:0xf bank_mask:0xf
    s_waitcnt vmcnt(4)
    buffer_load_dwordx4 v[140:143], v1, s[32:35], s87 offen offset:3072 nt
    v_mfma_f32_16x16x32_bf16 v[24:27], v[60:63], v[28:31], v[24:27]
    v_and_b32_dpp v32, v20, v2 row_newbcast:7 row_mask:0xf bank_mask:0xf
    v_and_b32_dpp v33, v20, v3 row_newbcast:7 row_mask:0xf bank_mask:0xf
    v_and_b32_dpp v34, v20, v4 row_newbcast:7 row_mask:0xf bank_mask:0xf
    v_and_b32_dpp v35, v20, v5 row_newbcast:7 row_mask:0xf bank_mask:0xf
    v_add_u32 v1, 16384, v1
    s_waitcnt vmcnt(4)
    buffer_load_dwordx4 v[144:147], v1, s[32:35], 0 offen offset:0 nt
    v_mfma_f32_16x16x32_bf16 v[24:27], v[64:67], v[32:35], v[24:27]
    v_and_b32_dpp v28, v20, v2 row_newbcast:8 row_mask:0xf bank_mask:0xf
    v_and_b32_dpp v29, v20, v3 row_newbcast:8 row_mask:0xf bank_mask:0xf
    v_and_b32_dpp v30, v20, v4 row_newbcast:8 row_mask:0xf bank_mask:0xf
    v_and_b32_dpp v31, v20, v5 row_newbcast:8 row_mask:0xf bank_mask:0xf
    s_waitcnt vmcnt(4)
    buffer_load_dwordx4 v[148:151], v1, s[32:35], s85 offen offset:2048 nt
    v_mfma_f32_16x16x32_bf16 v[24:27], v[128:131], v[28:31], v[24:27]
    v_and_b32_dpp v32, v20, v2 row_newbcast:9 row_mask:0xf bank_mask:0xf
    v_and_b32_dpp v33, v20, v3 row_newbcast:9 row_mask:0xf bank_mask:0xf
    v_and_b32_dpp v34, v20, v4 row_newbcast:9 row_mask:0xf bank_mask:0xf
    v_and_b32_dpp v35, v20, v5 row_newbcast:9 row_mask:0xf bank_mask:0xf
    s_waitcnt vmcnt(4)
    buffer_load_dwordx4 v[152:155], v1, s[32:35], 0 offen offset:1024 nt
    v_mfma_f32_16x16x32_bf16 v[24:27], v[132:135], v[32:35], v[24:27]
    v_and_b32_dpp v28, v20, v2 row_newbcast:10 row_mask:0xf bank_mask:0xf
    v_and_b32_dpp v29, v20, v3 row_newbcast:10 row_mask:0xf bank_mask:0xf
    v_and_b32_dpp v30, v20, v4 row_newbcast:10 row_mask:0xf bank_mask:0xf
    v_and_b32_dpp v31, v20, v5 row_newbcast:10 row_mask:0xf bank_mask:0xf
    s_waitcnt vmcnt(4)
    buffer_load_dwordx4 v[156:159], v1, s[32:35], s87 offen offset:3072 nt
    v_mfma_f32_16x16x32_bf16 v[24:27], v[136:139], v[28:31], v[24:27]
    v_and_b32_dpp v32, v20, v2 row_newbcast:11 row_mask:0xf bank_mask:0xf
    v_and_b32_dpp v33, v20, v3 row_newbcast:11 row_mask:0xf bank_mask:0xf
    v_and_b32_dpp v34, v20, v4 row_newbcast:11 row_mask:0xf bank_mask:0xf
    v_and_b32_dpp v35, v20, v5 row_newbcast:11 row_mask:0xf bank_mask:0xf
    v_add_u32 v1, 49152, v1
    s_waitcnt vmcnt(4)
    buffer_load_dwordx4 v[36:39], v1, s[32:35], 0 offen offset:0 nt
    v_mfma_f32_16x16x32_bf16 v[24:27], v[140:143], v[32:35], v[24:27]
    v_and_b32_dpp v28, v20, v2 row_newbcast:12 row_mask:0xf bank_mask:0xf
    v_and_b32_dpp v29, v20, v3 row_newbcast:12 row_mask:0xf bank_mask:0xf
    v_and_b32_dpp v30, v20, v4 row_newbcast:12 row_mask:0xf bank_mask:0xf
    v_and_b32_dpp v31, v20, v5 row_newbcast:12 row_mask:0xf bank_mask:0xf
    s_waitcnt vmcnt(4)
    buffer_load_dwordx4 v[40:43], v1, s[32:35], s85 offen offset:2048 nt
    v_mfma_f32_16x16x32_bf16 v[24:27], v[144:147], v[28:31], v[24:27]
    s_waitcnt lgkmcnt(0)
    v_fma_f32 v19, v104, s61, -v10
    ds_read_b64 v[108:109], v102
    ds_read_b32 v104, v103
    v_exp_f32 v19, v19
    v_add_u32 v103, 64, v103
    v_and_b32_dpp v32, v20, v2 row_newbcast:13 row_mask:0xf bank_mask:0xf
    v_and_b32_dpp v33, v20, v3 row_newbcast:13 row_mask:0xf bank_mask:0xf
    v_and_b32_dpp v34, v20, v4 row_newbcast:13 row_mask:0xf bank_mask:0xf
    v_and_b32_dpp v35, v20, v5 row_newbcast:13 row_mask:0xf bank_mask:0xf
    s_waitcnt vmcnt(4)
    buffer_load_dwordx4 v[44:47], v1, s[32:35], 0 offen offset:1024 nt
    v_mfma_f32_16x16x32_bf16 v[24:27], v[148:151], v[32:35], v[24:27]
    v_and_b32_dpp v28, v20, v2 row_newbcast:14 row_mask:0xf bank_mask:0xf
    v_and_b32_dpp v29, v20, v3 row_newbcast:14 row_mask:0xf bank_mask:0xf
    v_and_b32_dpp v30, v20, v4 row_newbcast:14 row_mask:0xf bank_mask:0xf
    v_and_b32_dpp v31, v20, v5 row_newbcast:14 row_mask:0xf bank_mask:0xf
    s_waitcnt vmcnt(4)
    buffer_load_dwordx4 v[48:51], v1, s[32:35], s87 offen offset:3072 nt
    v_mfma_f32_16x16x32_bf16 v[24:27], v[152:155], v[28:31], v[24:27]
    v_and_b32_dpp v32, v20, v2 row_newbcast:15 row_mask:0xf bank_mask:0xf
    v_and_b32_dpp v33, v20, v3 row_newbcast:15 row_mask:0xf bank_mask:0xf
    v_and_b32_dpp v34, v20, v4 row_newbcast:15 row_mask:0xf bank_mask:0xf
    v_and_b32_dpp v35, v20, v5 row_newbcast:15 row_mask:0xf bank_mask:0xf
    v_cvt_pk_bf16_f32 v20, v19, v19
    v_add_u32 v1, 16384, v1
    s_waitcnt vmcnt(4)
    buffer_load_dwordx4 v[52:55], v1, s[32:35], 0 offen offset:0 nt
    v_mfma_f32_16x16x32_bf16 v[24:27], v[156:159], v[32:35], v[24:27]
    v_and_b32_dpp v28, v20, v2 row_newbcast:0 row_mask:0xf bank_mask:0xf
    v_and_b32_dpp v29, v20, v3 row_newbcast:0 row_mask:0xf bank_mask:0xf
    v_and_b32_dpp v30, v20, v4 row_newbcast:0 row_mask:0xf bank_mask:0xf
    v_and_b32_dpp v31, v20, v5 row_newbcast:0 row_mask:0xf bank_mask:0xf
L_vnext:
    s_waitcnt lgkmcnt(1)
    v_readfirstlane_b32 s58, v108
    s_sub_u32 s57, s57, 1
    s_cmp_eq_u32 s57, 0
    s_cbranch_scc1 L_vdone
    s_cmp_le_i32 s57, s58
    s_cbranch_scc1 L_vloop
    ds_write_b32 v101, v1
    s_waitcnt vmcnt(4)
    buffer_load_dwordx4 v[56:59], v1, s[32:35], s85 offen offset:2048 nt
    buffer_load_dwordx4 v[60:63], v1, s[32:35], 0 offen offset:1024 nt
    v_mfma_f32_16x16x32_bf16 v[24:27], v[36:39], v[28:31], v[24:27]
    v_and_b32_dpp v32, v20, v2 row_newbcast:1 row_mask:0xf bank_mask:0xf
    v_and_b32_dpp v33, v20, v3 row_newbcast:1 row_mask:0xf bank_mask:0xf
    v_and_b32_dpp v34, v20, v4 row_newbcast:1 row_mask:0xf bank_mask:0xf
    v_and_b32_dpp v35, v20, v5 row_newbcast:1 row_mask:0xf bank_mask:0xf
    s_waitcnt vmcnt(5)
    buffer_load_dwordx4 v[64:67], v1, s[32:35], s87 offen offset:3072 nt
    v_mfma_f32_16x16x32_bf16 v[24:27], v[40:43], v[32:35], v[24:27]
    v_and_b32_dpp v28, v20, v2 row_newbcast:2 row_mask:0xf bank_mask:0xf
    v_and_b32_dpp v29, v20, v3 row_newbcast:2 row_mask:0xf bank_mask:0xf
    v_and_b32_dpp v30, v20, v4 row_newbcast:2 row_mask:0xf bank_mask:0xf
    v_and_b32_dpp v31, v20, v5 row_newbcast:2 row_mask:0xf bank_mask:0xf
    v_add_u32 v1, 49152, v1
    s_waitcnt vmcnt(5)
    buffer_load_dwordx4 v[128:131], v1, s[32:35], 0 offen offset:0 nt
    v_mfma_f32_16x16x32_bf16 v[24:27], v[44:47], v[28:31], v[24:27]
    v_and_b32_dpp v32, v20, v2 row_newbcast:3 row_mask:0xf bank_mask:0xf
    v_and_b32_dpp v33, v20, v3 row_newbcast:3 row_mask:0xf bank_mask:0xf
    v_and_b32_dpp v34, v20, v4 row_newbcast:3 row_mask:0xf bank_mask:0xf
    v_and_b32_dpp v35, v20, v5 row_newbcast:3 row_mask:0xf bank_mask:0xf
    s_waitcnt vmcnt(5)
    buffer_load_dwordx4 v[132:135], v1, s[32:35], s85 offen offset:2048 nt
    v_mfma_f32_16x16x32_bf16 v[24:27], v[48:51], v[32:35], v[24:27]
    v_and_b32_dpp v28, v20, v2 row_newbcast:4 row_mask:0xf bank_mask:0xf
    v_and_b32_dpp v29, v20, v3 row_newbcast:4 row_mask:0xf bank_mask:0xf
    v_and_b32_dpp v30, v20, v4 row_newbcast:4 row_mask:0xf bank_mask:0xf
    v_and_b32_dpp v31, v20, v5 row_newbcast:4 row_mask:0xf bank_mask:0xf
    s_waitcnt vmcnt(5)
    buffer_load_dwordx4 v[136:139], v1, s[32:35], 0 offen offset:1024 nt
    v_mfma_f32_16x16x32_bf16 v[24:27], v[52:55], v[28:31], v[24:27]
    v_and_b32_dpp v32, v20, v2 row_newbcast:5 row_mask:0xf bank_mask:0xf
    v_and_b32_dpp v33, v20, v3 row_newbcast:5 row_mask:0xf bank_mask:0xf
    v_and_b32_dpp v34, v20, v4 row_newbcast:5 row_mask:0xf bank_mask:0xf
    v_and_b32_dpp v35, v20, v5 row_newbcast:5 row_mask:0xf bank_mask:0xf
    s_waitcnt vmcnt(5)
    buffer_load_dwordx4 v[140:143], v1, s[32:35], s87 offen offset:3072 nt
    v_mfma_f32_16x16x32_bf16 v[24:27], v[56:59], v[32:35], v[24:27]
    v_and_b32_dpp v28, v20, v2 row_newbcast:6 row_mask:0xf bank_mask:0xf
    v_and_b32_dpp v29, v20, v3 row_newbcast:6 row_mask:0xf bank_mask:0xf
    v_and_b32_dpp v30, v20, v4 row_newbcast:6 row_mask:0xf bank_mask:0xf
    v_and_b32_dpp v31, v20, v5 row_newbcast:6 row_mask:0xf bank_mask:0xf
    v_add_u32 v1, 16384, v1
    s_waitcnt vmcnt(5)
    buffer_load_dwordx4 v[144:147], v1, s[32:35], 0 offen offset:0 nt
    v_mfma_f32_16x16x32_bf16 v[24:27], v[60:63], v[28:31], v[24:27]
    v_and_b32_dpp v32, v20, v2 row_newbcast:7 row_mask:0xf bank_mask:0xf
    v_and_b32_dpp v33, v20, v3 row_newbcast:7 row_mask:0xf bank_mask:0xf
    v_and_b32_dpp v34, v20, v4 row_newbcast:7 row_mask:0xf bank_mask:0xf
    v_and_b32_dpp v35, v20, v5 row_newbcast:7 row_mask:0xf bank_mask:0xf
    s_waitcnt vmcnt(5)
    buffer_load_dwordx4 v[148:151], v1, s[32:35], s85 offen offset:2048 nt
    v_mfma_f32_16x16x32_bf16 v[24:27], v[64:67], v[32:35], v[24:27]
    v_and_b32_dpp v28, v20, v2 row_newbcast:8 row_mask:0xf bank_mask:0xf
    v_and_b32_dpp v29, v20, v3 row_newbcast:8 row_mask:0xf bank_mask:0xf
    v_and_b32_dpp v30, v20, v4 row_newbcast:8 row_mask:0xf bank_mask:0xf
    v_and_b32_dpp v31, v20, v5 row_newbcast:8 row_mask:0xf bank_mask:0xf
    s_waitcnt vmcnt(5)
    buffer_load_dwordx4 v[152:155], v1, s[32:35], 0 offen offset:1024 nt
    v_mfma_f32_16x16x32_bf16 v[24:27], v[128:131], v[28:31], v[24:27]
    v_and_b32_dpp v32, v20, v2 row_newbcast:9 row_mask:0xf bank_mask:0xf
    v_and_b32_dpp v33, v20, v3 row_newbcast:9 row_mask:0xf bank_mask:0xf
    v_and_b32_dpp v34, v20, v4 row_newbcast:9 row_mask:0xf bank_mask:0xf
    v_and_b32_dpp v35, v20, v5 row_newbcast:9 row_mask:0xf bank_mask:0xf
    s_waitcnt vmcnt(5)
    buffer_load_dwordx4 v[156:159], v1, s[32:35], s87 offen offset:3072 nt
    v_mfma_f32_16x16x32_bf16 v[24:27], v[132:135], v[32:35], v[24:27]
    v_and_b32_dpp v28, v20, v2 row_newbcast:10 row_mask:0xf bank_mask:0xf
    v_and_b32_dpp v29, v20, v3 row_newbcast:10 row_mask:0xf bank_mask:0xf
    v_and_b32_dpp v30, v20, v4 row_newbcast:10 row_mask:0xf bank_mask:0xf
    v_and_b32_dpp v31, v20, v5 row_newbcast:10 row_mask:0xf bank_mask:0xf
    v_add_u32 v1, 49152, v1
    s_waitcnt vmcnt(5)
    buffer_load_dwordx4 v[36:39], v1, s[32:35], 0 offen offset:0 nt
    v_mfma_f32_16x16x32_bf16 v[24:27], v[136:139], v[28:31], v[24:27]
    v_and_b32_dpp v32, v20, v2 row_newbcast:11 row_mask:0xf bank_mask:0xf
    v_and_b32_dpp v33, v20, v3 row_newbcast:11 row_mask:0xf bank_mask:0xf
    v_and_b32_dpp v34, v20, v4 row_newbcast:11 row_mask:0xf bank_mask:0xf
    v_and_b32_dpp v35, v20, v5 row_newbcast:11 row_mask:0xf bank_mask:0xf
    s_waitcnt vmcnt(5)
    buffer_load_dwordx4 v[40:43], v1, s[32:35], s85 offen offset:2048 nt
    v_mfma_f32_16x16x32_bf16 v[24:27], v[140:143], v[32:35], v[24:27]
    v_and_b32_dpp v28, v20, v2 row_newbcast:12 row_mask:0xf bank_mask:0xf
    v_and_b32_dpp v29, v20, v3 row_newbcast:12 row_mask:0xf bank_mask:0xf
    v_and_b32_dpp v30, v20, v4 row_newbcast:12 row_mask:0xf bank_mask:0xf
    v_and_b32_dpp v31, v20, v5 row_newbcast:12 row_mask:0xf bank_mask:0xf
    s_waitcnt vmcnt(5)
    buffer_load_dwordx4 v[44:47], v1, s[32:35], 0 offen offset:1024 nt
    v_mfma_f32_16x16x32_bf16 v[24:27], v[144:147], v[28:31], v[24:27]
    s_waitcnt lgkmcnt(0)
    v_fma_f32 v19, v104, s61, -v10
    ds_read_b64 v[108:109], v102
    ds_read_b32 v104, v103
    v_exp_f32 v19, v19
    v_add_u32 v103, 64, v103
    v_and_b32_dpp v32, v20, v2 row_newbcast:13 row_mask:0xf bank_mask:0xf
    v_and_b32_dpp v33, v20, v3 row_newbcast:13 row_mask:0xf bank_mask:0xf
    v_and_b32_dpp v34, v20, v4 row_newbcast:13 row_mask:0xf bank_mask:0xf
    v_and_b32_dpp v35, v20, v5 row_newbcast:13 row_mask:0xf bank_mask:0xf
    s_waitcnt vmcnt(5)
    buffer_load_dwordx4 v[48:51], v1, s[32:35], s87 offen offset:3072 nt
    v_mfma_f32_16x16x32_bf16 v[24:27], v[148:151], v[32:35], v[24:27]
    v_and_b32_dpp v28, v20, v2 row_newbcast:14 row_mask:0xf bank_mask:0xf
    v_and_b32_dpp v29, v20, v3 row_newbcast:14 row_mask:0xf bank_mask:0xf
    v_and_b32_dpp v30, v20, v4 row_newbcast:14 row_mask:0xf bank_mask:0xf
    v_and_b32_dpp v31, v20, v5 row_newbcast:14 row_mask:0xf bank_mask:0xf
    v_add_u32 v1, 16384, v1
    s_waitcnt vmcnt(5)
    buffer_load_dwordx4 v[52:55], v1, s[32:35], 0 offen offset:0 nt
    v_mfma_f32_16x16x32_bf16 v[24:27], v[152:155], v[28:31], v[24:27]
    v_and_b32_dpp v32, v20, v2 row_newbcast:15 row_mask:0xf bank_mask:0xf
    v_and_b32_dpp v33, v20, v3 row_newbcast:15 row_mask:0xf bank_mask:0xf
    v_and_b32_dpp v34, v20, v4 row_newbcast:15 row_mask:0xf bank_mask:0xf
    v_and_b32_dpp v35, v20, v5 row_newbcast:15 row_mask:0xf bank_mask:0xf
    v_cvt_pk_bf16_f32 v20, v19, v19
    s_waitcnt vmcnt(5)
    s_nop 0
    v_mfma_f32_16x16x32_bf16 v[24:27], v[156:159], v[32:35], v[24:27]
    v_and_b32_dpp v28, v20, v2 row_newbcast:0 row_mask:0xf bank_mask:0xf
    v_and_b32_dpp v29, v20, v3 row_newbcast:0 row_mask:0xf bank_mask:0xf
    v_and_b32_dpp v30, v20, v4 row_newbcast:0 row_mask:0xf bank_mask:0xf
    v_and_b32_dpp v31, v20, v5 row_newbcast:0 row_mask:0xf bank_mask:0xf
    s_branch L_vnext
.p2align 12
L_vdone:
    buffer_load_dwordx4 v[56:59], v1, s[32:35], s85 offen offset:2048 nt
    buffer_load_dwordx4 v[60:63], v1, s[32:35], 0 offen offset:1024 nt
    buffer_load_dwordx4 v[64:67], v1, s[32:35], s87 offen offset:3072 nt
    v_add_u32 v1, 49152, v1
    buffer_load_dwordx4 v[128:131], v1, s[32:35], 0 offen offset:0 nt
    buffer_load_dwordx4 v[132:135], v1, s[32:35], s85 offen offset:2048 nt
    s_cmp_eq_u32 s65, 0
    s_cbranch_scc1 L_vlast
L_vloop2:
    ds_write_b32 v101, v1
    s_waitcnt vmcnt(9)
    buffer_load_dwordx4 v[136:139], v1, s[32:35], 0 offen offset:1024 nt
    v_mfma_f32_16x16x32_bf16 v[24:27], v[36:39], v[28:31], v[24:27]
    v_and_b32_dpp v32, v20, v2 row_newbcast:1 row_mask:0xf bank_mask:0xf
    v_and_b32_dpp v33, v20, v3 row_newbcast:1 row_mask:0xf bank_mask:0xf
    v_and_b32_dpp v34, v20, v4 row_newbcast:1 row_mask:0xf bank_mask:0xf
    v_and_b32_dpp v35, v20, v5 row_newbcast:1 row_mask:0xf bank_mask:0xf
    s_waitcnt vmcnt(9)
    buffer_load_dwordx4 v[140:143], v1, s[32:35], s87 offen offset:3072 nt
    v_mfma_f32_16x16x32_bf16 v[24:27], v[40:43], v[32:35], v[24:27]
    v_and_b32_dpp v28, v20, v2 row_newbcast:2 row_mask:0xf bank_mask:0xf
    v_and_b32_dpp v29, v20, v3 row_newbcast:2 row_mask:0xf bank_mask:0xf
    v_and_b32_dpp v30, v20, v4 row_newbcast:2 row_mask:0xf bank_mask:0xf
    v_and_b32_dpp v31, v20, v5 row_newbcast:2 row_mask:0xf bank_mask:0xf
    v_add_u32 v1, 16384, v1
    s_waitcnt vmcnt(9)
    buffer_load_dwordx4 v[144:147], v1, s[32:35], 0 offen offset:0 nt
    v_mfma_f32_16x16x32_bf16 v[24:27], v[44:47], v[28:31], v[24:27]
    v_and_b32_dpp v32, v20, v2 row_newbcast:3 row_mask:0xf bank_mask:0xf
    v_and_b32_dpp v33, v20, v3 row_newbcast:3 row_mask:0xf bank_mask:0xf
    v_and_b32_dpp v34, v20, v4 row_newbcast:3 row_mask:0xf bank_mask:0xf
    v_and_b32_dpp v35, v20, v5 row_newbcast:3 row_mask:0xf bank_mask:0xf
    s_waitcnt vmcnt(9)
    buffer_load_dwordx4 v[148:151], v1, s[32:35], s85 offen offset:2048 nt
    v_mfma_f32_16x16x32_bf16 v[24:27], v[48:51], v[32:35], v[24:27]
    v_and_b32_dpp v28, v20, v2 row_newbcast:4 row_mask:0xf bank_mask:0xf
    v_and_b32_dpp v29, v20, v3 row_newbcast:4 row_mask:0xf bank_mask:0xf
    v_and_b32_dpp v30, v20, v4 row_newbcast:4 row_mask:0xf bank_mask:0xf
    v_and_b32_dpp v31, v20, v5 row_newbcast:4 row_mask:0xf bank_mask:0xf
    s_waitcnt vmcnt(9)
    buffer_load_dwordx4 v[152:155], v1, s[32:35], 0 offen offset:1024 nt
    v_mfma_f32_16x16x32_bf16 v[24:27], v[52:55], v[28:31], v[24:27]
    v_and_b32_dpp v32, v20, v2 row_newbcast:5 row_mask:0xf bank_mask:0xf
    v_and_b32_dpp v33, v20, v3 row_newbcast:5 row_mask:0xf bank_mask:0xf
    v_and_b32_dpp v34, v20, v4 row_newbcast:5 row_mask:0xf bank_mask:0xf
    v_and_b32_dpp v35, v20, v5 row_newbcast:5 row_mask:0xf bank_mask:0xf
    s_waitcnt vmcnt(9)
    buffer_load_dwordx4 v[156:159], v1, s[32:35], s87 offen offset:3072 nt
    v_mfma_f32_16x16x32_bf16 v[24:27], v[56:59], v[32:35], v[24:27]
    v_and_b32_dpp v28, v20, v2 row_newbcast:6 row_mask:0xf bank_mask:0xf
    v_and_b32_dpp v29, v20, v3 row_newbcast:6 row_mask:0xf bank_mask:0xf
    v_and_b32_dpp v30, v20, v4 row_newbcast:6 row_mask:0xf bank_mask:0xf
    v_and_b32_dpp v31, v20, v5 row_newbcast:6 row_mask:0xf bank_mask:0xf
    v_add_u32 v1, 49152, v1
    s_waitcnt vmcnt(9)
    buffer_load_dwordx4 v[36:39], v1, s[32:35], 0 offen offset:0 nt
    v_mfma_f32_16x16x32_bf16 v[24:27], v[60:63], v[28:31], v[24:27]
    v_and_b32_dpp v32, v20, v2 row_newbcast:7 row_mask:0xf bank_mask:0xf
    v_and_b32_dpp v33, v20, v3 row_newbcast:7 row_mask:0xf bank_mask:0xf
    v_and_b32_dpp v34, v20, v4 row_newbcast:7 row_mask:0xf bank_mask:0xf
    v_and_b32_dpp v35, v20, v5 row_newbcast:7 row_mask:0xf bank_mask:0xf
    s_waitcnt vmcnt(9)
    buffer_load_dwordx4 v[40:43], v1, s[32:35], s85 offen offset:2048 nt
    v_mfma_f32_16x16x32_bf16 v[24:27], v[64:67], v[32:35], v[24:27]
    v_and_b32_dpp v28, v20, v2 row_newbcast:8 row_mask:0xf bank_mask:0xf
    v_and_b32_dpp v29, v20, v3 row_newbcast:8 row_mask:0xf bank_mask:0xf
    v_and_b32_dpp v30, v20, v4 row_newbcast:8 row_mask:0xf bank_mask:0xf
    v_and_b32_dpp v31, v20, v5 row_newbcast:8 row_mask:0xf bank_mask:0xf
    s_waitcnt vmcnt(9)
    buffer_load_dwordx4 v[44:47], v1, s[32:35], 0 offen offset:1024 nt
    v_mfma_f32_16x16x32_bf16 v[24:27], v[128:131], v[28:31], v[24:27]
    v_and_b32_dpp v32, v20, v2 row_newbcast:9 row_mask:0xf bank_mask:0xf
    v_and_b32_dpp v33, v20, v3 row_newbcast:9 row_mask:0xf bank_mask:0xf
    v_and_b32_dpp v34, v20, v4 row_newbcast:9 row_mask:0xf bank_mask:0xf
    v_and_b32_dpp v35, v20, v5 row_newbcast:9 row_mask:0xf bank_mask:0xf
    s_waitcnt vmcnt(9)
    buffer_load_dwordx4 v[48:51], v1, s[32:35], s87 offen offset:3072 nt
    v_mfma_f32_16x16x32_bf16 v[24:27], v[132:135], v[32:35], v[24:27]
    v_and_b32_dpp v28, v20, v2 row_newbcast:10 row_mask:0xf bank_mask:0xf
    v_and_b32_dpp v29, v20, v3 row_newbcast:10 row_mask:0xf bank_mask:0xf
    v_and_b32_dpp v30, v20, v4 row_newbcast:10 row_mask:0xf bank_mask:0xf
    v_and_b32_dpp v31, v20, v5 row_newbcast:10 row_mask:0xf bank_mask:0xf
    v_add_u32 v1, 16384, v1
    s_waitcnt vmcnt(9)
    buffer_load_dwordx4 v[52:55], v1, s[32:35], 0 offen offset:0 nt
    v_mfma_f32_16x16x32_bf16 v[24:27], v[136:139], v[28:31], v[24:27]
    v_and_b32_dpp v32, v20, v2 row_newbcast:11 row_mask:0xf bank_mask:0xf
    v_and_b32_dpp v33, v20, v3 row_newbcast:11 row_mask:0xf bank_mask:0xf
    v_and_b32_dpp v34, v20, v4 row_newbcast:11 row_mask:0xf bank_mask:0xf
    v_and_b32_dpp v35, v20, v5 row_newbcast:11 row_mask:0xf bank_mask:0xf
    s_waitcnt vmcnt(9)
    buffer_load_dwordx4 v[56:59], v1, s[32:35], s85 offen offset:2048 nt
    v_mfma_f32_16x16x32_bf16 v[24:27], v[140:143], v[32:35], v[24:27]
    v_and_b32_dpp v28, v20, v2 row_newbcast:12 row_mask:0xf bank_mask:0xf
    v_and_b32_dpp v29, v20, v3 row_newbcast:12 row_mask:0xf bank_mask:0xf
    v_and_b32_dpp v30, v20, v4 row_newbcast:12 row_mask:0xf bank_mask:0xf
    v_and_b32_dpp v31, v20, v5 row_newbcast:12 row_mask:0xf bank_mask:0xf
    s_waitcnt vmcnt(9)
    buffer_load_dwordx4 v[60:63], v1, s[32:35], 0 offen offset:1024 nt
    v_mfma_f32_16x16x32_bf16 v[24:27], v[144:147], v[28:31], v[24:27]
    s_waitcnt lgkmcnt(0)
    v_fma_f32 v19, v104, s61, -v10
    ds_read_b64 v[108:109], v102
    ds_read_b32 v104, v103
    v_exp_f32 v19, v19
    v_add_u32 v103, 64, v103
    v_and_b32_dpp v32, v20, v2 row_newbcast:13 row_mask:0xf bank_mask:0xf
    v_and_b32_dpp v33, v20, v3 row_newbcast:13 row_mask:0xf bank_mask:0xf
    v_and_b32_dpp v34, v20, v4 row_newbcast:13 row_mask:0xf bank_mask:0xf
    v_and_b32_dpp v35, v20, v5 row_newbcast:13 row_mask:0xf bank_mask:0xf
    s_waitcnt vmcnt(9)
    buffer_load_dwordx4 v[64:67], v1, s[32:35], s87 offen offset:3072 nt
    v_mfma_f32_16x16x32_bf16 v[24:27], v[148:151], v[32:35], v[24:27]
    v_and_b32_dpp v28, v20, v2 row_newbcast:14 row_mask:0xf bank_mask:0xf
    v_and_b32_dpp v29, v20, v3 row_newbcast:14 row_mask:0xf bank_mask:0xf
    v_and_b32_dpp v30, v20, v4 row_newbcast:14 row_mask:0xf bank_mask:0xf
    v_and_b32_dpp v31, v20, v5 row_newbcast:14 row_mask:0xf bank_mask:0xf
    v_add_u32 v1, 49152, v1
    s_waitcnt vmcnt(9)
    buffer_load_dwordx4 v[128:131], v1, s[32:35], 0 offen offset:0 nt
    v_mfma_f32_16x16x32_bf16 v[24:27], v[152:155], v[28:31], v[24:27]
    v_and_b32_dpp v32, v20, v2 row_newbcast:15 row_mask:0xf bank_mask:0xf
    v_and_b32_dpp v33, v20, v3 row_newbcast:15 row_mask:0xf bank_mask:0xf
    v_and_b32_dpp v34, v20, v4 row_newbcast:15 row_mask:0xf bank_mask:0xf
    v_and_b32_dpp v35, v20, v5 row_newbcast:15 row_mask:0xf bank_mask:0xf
    v_cvt_pk_bf16_f32 v20, v19, v19
    s_waitcnt vmcnt(9)
    buffer_load_dwordx4 v[132:135], v1, s[32:35], s85 offen offset:2048 nt
    v_mfma_f32_16x16x32_bf16 v[24:27], v[156:159], v[32:35], v[24:27]
    v_and_b32_dpp v28, v20, v2 row_newbcast:0 row_mask:0xf bank_mask:0xf
    v_and_b32_dpp v29, v20, v3 row_newbcast:0 row_mask:0xf bank_mask:0xf
    v_and_b32_dpp v30, v20, v4 row_newbcast:0 row_mask:0xf bank_mask:0xf
    v_and_b32_dpp v31, v20, v5 row_newbcast:0 row_mask:0xf bank_mask:0xf
    s_sub_u32 s65, s65, 1
    s_cmp_lg_u32 s65, 0
    s_cbranch_scc1 L_vloop2
L_vlast:
    v_mov_b32 v21, 156720
    s_lshl_b32 s58, s55, 2
    v_add_u32 v22, s58, v21
    s_mov_b32 s57, 262144
L_fchk:
    ds_read_b32 v108, v21 offset:20
    ds_read_b32 v109, v22
    s_waitcnt lgkmcnt(0)
    v_readfirstlane_b32 s58, v108
    s_nop 1
    s_cmp_eq_u32 s58, 1
    s_cbranch_scc1 L_fok
    s_sub_u32 s57, s57, 1
    s_cmp_lg_u32 s57, 0
    s_cbranch_scc1 L_fchk
L_fok:
    v_lshrrev_b32 v21, 4, v0
    v_and_b32 v22, 7, v0
    v_lshl_add_u32 v21, v21, 3, v22
    s_mul_i32 s58, s55, 272
    s_add_u32 s58, s58, 135168
    v_lshl_add_u32 v100, v21, 3, s58
    s_mov_b32 s40, s28
    s_mov_b32 s41, s29
    s_mov_b32 s42, 2097152
    s_mov_b32 s43, 0x20000
    s_mov_b32 s44, s24
    s_mov_b32 s45, s25
    s_mov_b32 s46, 4096
    s_mov_b32 s47, 0x20000
    ds_write_b32 v101, v1
    s_waitcnt vmcnt(9)
    buffer_load_dwordx4 v[136:139], v1, s[32:35], 0 offen offset:1024 nt
    v_mfma_f32_16x16x32_bf16 v[24:27], v[36:39], v[28:31], v[24:27]
    v_and_b32_dpp v32, v20, v2 row_newbcast:1 row_mask:0xf bank_mask:0xf
    v_and_b32_dpp v33, v20, v3 row_newbcast:1 row_mask:0xf bank_mask:0xf
    v_and_b32_dpp v34, v20, v4 row_newbcast:1 row_mask:0xf bank_mask:0xf
    v_and_b32_dpp v35, v20, v5 row_newbcast:1 row_mask:0xf bank_mask:0xf
    s_waitcnt vmcnt(9)
    buffer_load_dwordx4 v[140:143], v1, s[32:35], s87 offen offset:3072 nt
    v_mfma_f32_16x16x32_bf16 v[24:27], v[40:43], v[32:35], v[24:27]
    v_and_b32_dpp v28, v20, v2 row_newbcast:2 row_mask:0xf bank_mask:0xf
    v_and_b32_dpp v29, v20, v3 row_newbcast:2 row_mask:0xf bank_mask:0xf
    v_and_b32_dpp v30, v20, v4 row_newbcast:2 row_mask:0xf bank_mask:0xf
    v_and_b32_dpp v31, v20, v5 row_newbcast:2 row_mask:0xf bank_mask:0xf
    v_add_u32 v1, 16384, v1
    s_waitcnt vmcnt(9)
    buffer_load_dwordx4 v[144:147], v1, s[32:35], 0 offen offset:0 nt
    v_mfma_f32_16x16x32_bf16 v[24:27], v[44:47], v[28:31], v[24:27]
    v_and_b32_dpp v32, v20, v2 row_newbcast:3 row_mask:0xf bank_mask:0xf
    v_and_b32_dpp v33, v20, v3 row_newbcast:3 row_mask:0xf bank_mask:0xf
    v_and_b32_dpp v34, v20, v4 row_newbcast:3 row_mask:0xf bank_mask:0xf
    v_and_b32_dpp v35, v20, v5 row_newbcast:3 row_mask:0xf bank_mask:0xf
    s_waitcnt vmcnt(9)
    buffer_load_dwordx4 v[148:151], v1, s[32:35], s85 offen offset:2048 nt
    v_mfma_f32_16x16x32_bf16 v[24:27], v[48:51], v[32:35], v[24:27]
    v_and_b32_dpp v28, v20, v2 row_newbcast:4 row_mask:0xf bank_mask:0xf
    v_and_b32_dpp v29, v20, v3 row_newbcast:4 row_mask:0xf bank_mask:0xf
    v_and_b32_dpp v30, v20, v4 row_newbcast:4 row_mask:0xf bank_mask:0xf
    v_and_b32_dpp v31, v20, v5 row_newbcast:4 row_mask:0xf bank_mask:0xf
    s_waitcnt vmcnt(9)
    buffer_load_dwordx4 v[152:155], v1, s[32:35], 0 offen offset:1024 nt
    v_mfma_f32_16x16x32_bf16 v[24:27], v[52:55], v[28:31], v[24:27]
    v_and_b32_dpp v32, v20, v2 row_newbcast:5 row_mask:0xf bank_mask:0xf
    v_and_b32_dpp v33, v20, v3 row_newbcast:5 row_mask:0xf bank_mask:0xf
    v_and_b32_dpp v34, v20, v4 row_newbcast:5 row_mask:0xf bank_mask:0xf
    v_and_b32_dpp v35, v20, v5 row_newbcast:5 row_mask:0xf bank_mask:0xf
    s_waitcnt vmcnt(9)
    buffer_load_dwordx4 v[156:159], v1, s[32:35], s87 offen offset:3072 nt
    v_mfma_f32_16x16x32_bf16 v[24:27], v[56:59], v[32:35], v[24:27]
    v_and_b32_dpp v28, v20, v2 row_newbcast:6 row_mask:0xf bank_mask:0xf
    v_and_b32_dpp v29, v20, v3 row_newbcast:6 row_mask:0xf bank_mask:0xf
    v_and_b32_dpp v30, v20, v4 row_newbcast:6 row_mask:0xf bank_mask:0xf
    v_and_b32_dpp v31, v20, v5 row_newbcast:6 row_mask:0xf bank_mask:0xf
    s_waitcnt vmcnt(9)
    s_nop 0
    v_mfma_f32_16x16x32_bf16 v[24:27], v[60:63], v[28:31], v[24:27]
    v_and_b32_dpp v32, v20, v2 row_newbcast:7 row_mask:0xf bank_mask:0xf
    v_and_b32_dpp v33, v20, v3 row_newbcast:7 row_mask:0xf bank_mask:0xf
    v_and_b32_dpp v34, v20, v4 row_newbcast:7 row_mask:0xf bank_mask:0xf
    v_and_b32_dpp v35, v20, v5 row_newbcast:7 row_mask:0xf bank_mask:0xf
    s_waitcnt vmcnt(8)
    s_nop 0
    v_mfma_f32_16x16x32_bf16 v[24:27], v[64:67], v[32:35], v[24:27]
    v_and_b32_dpp v28, v20, v2 row_newbcast:8 row_mask:0xf bank_mask:0xf
    v_and_b32_dpp v29, v20, v3 row_newbcast:8 row_mask:0xf bank_mask:0xf
    v_and_b32_dpp v30, v20, v4 row_newbcast:8 row_mask:0xf bank_mask:0xf
    v_and_b32_dpp v31, v20, v5 row_newbcast:8 row_mask:0xf bank_mask:0xf
    s_waitcnt vmcnt(7)
    s_nop 0
    v_mfma_f32_16x16x32_bf16 v[24:27], v[128:131], v[28:31], v[24:27]
    v_and_b32_dpp v32, v20, v2 row_newbcast:9 row_mask:0xf bank_mask:0xf
    v_and_b32_dpp v33, v20, v3 row_newbcast:9 row_mask:0xf bank_mask:0xf
    v_and_b32_dpp v34, v20, v4 row_newbcast:9 row_mask:0xf bank_mask:0xf
    v_and_b32_dpp v35, v20, v5 row_newbcast:9 row_mask:0xf bank_mask:0xf
    s_waitcnt vmcnt(6)
    s_nop 0
    v_mfma_f32_16x16x32_bf16 v[24:27], v[132:135], v[32:35], v[24:27]
    v_and_b32_dpp v28, v20, v2 row_newbcast:10 row_mask:0xf bank_mask:0xf
    v_and_b32_dpp v29, v20, v3 row_newbcast:10 row_mask:0xf bank_mask:0xf
    v_and_b32_dpp v30, v20, v4 row_newbcast:10 row_mask:0xf bank_mask:0xf
    v_and_b32_dpp v31, v20, v5 row_newbcast:10 row_mask:0xf bank_mask:0xf
    s_waitcnt vmcnt(5)
    s_nop 0
    v_mfma_f32_16x16x32_bf16 v[24:27], v[136:139], v[28:31], v[24:27]
    v_and_b32_dpp v32, v20, v2 row_newbcast:11 row_mask:0xf bank_mask:0xf
    v_and_b32_dpp v33, v20, v3 row_newbcast:11 row_mask:0xf bank_mask:0xf
    v_and_b32_dpp v34, v20, v4 row_newbcast:11 row_mask:0xf bank_mask:0xf
    v_and_b32_dpp v35, v20, v5 row_newbcast:11 row_mask:0xf bank_mask:0xf
    s_waitcnt vmcnt(4)
    s_nop 0
    v_mfma_f32_16x16x32_bf16 v[24:27], v[140:143], v[32:35], v[24:27]
    v_and_b32_dpp v28, v20, v2 row_newbcast:12 row_mask:0xf bank_mask:0xf
    v_and_b32_dpp v29, v20, v3 row_newbcast:12 row_mask:0xf bank_mask:0xf
    v_and_b32_dpp v30, v20, v4 row_newbcast:12 row_mask:0xf bank_mask:0xf
    v_and_b32_dpp v31, v20, v5 row_newbcast:12 row_mask:0xf bank_mask:0xf
    s_waitcnt vmcnt(3)
    s_nop 0
    v_mfma_f32_16x16x32_bf16 v[24:27], v[144:147], v[28:31], v[24:27]
    v_and_b32_dpp v32, v20, v2 row_newbcast:13 row_mask:0xf bank_mask:0xf
    v_and_b32_dpp v33, v20, v3 row_newbcast:13 row_mask:0xf bank_mask:0xf
    v_and_b32_dpp v34, v20, v4 row_newbcast:13 row_mask:0xf bank_mask:0xf
    v_and_b32_dpp v35, v20, v5 row_newbcast:13 row_mask:0xf bank_mask:0xf
    s_waitcnt vmcnt(2)
    s_nop 0
    v_mfma_f32_16x16x32_bf16 v[24:27], v[148:151], v[32:35], v[24:27]
    v_and_b32_dpp v28, v20, v2 row_newbcast:14 row_mask:0xf bank_mask:0xf
    v_and_b32_dpp v29, v20, v3 row_newbcast:14 row_mask:0xf bank_mask:0xf
    v_and_b32_dpp v30, v20, v4 row_newbcast:14 row_mask:0xf bank_mask:0xf
    v_and_b32_dpp v31, v20, v5 row_newbcast:14 row_mask:0xf bank_mask:0xf
    s_waitcnt vmcnt(1)
    s_nop 0
    v_mfma_f32_16x16x32_bf16 v[24:27], v[152:155], v[28:31], v[24:27]
    v_and_b32_dpp v32, v20, v2 row_newbcast:15 row_mask:0xf bank_mask:0xf
    v_and_b32_dpp v33, v20, v3 row_newbcast:15 row_mask:0xf bank_mask:0xf
    v_and_b32_dpp v34, v20, v4 row_newbcast:15 row_mask:0xf bank_mask:0xf
    v_and_b32_dpp v35, v20, v5 row_newbcast:15 row_mask:0xf bank_mask:0xf
    s_waitcnt vmcnt(0)
    s_nop 0
    v_mfma_f32_16x16x32_bf16 v[24:27], v[156:159], v[32:35], v[24:27]
L_vend:
    s_nop 5
    s_mov_b32 exec_lo, 0x00ff00ff
    s_mov_b32 exec_hi, 0x00ff00ff
    v_mul_f32 v24, v24, v109
    v_mul_f32 v25, v25, v109
    v_mul_f32 v26, v26, v109
    v_mul_f32 v27, v27, v109
    v_cvt_pk_bf16_f32 v24, v24, v25
    v_cvt_pk_bf16_f32 v25, v26, v27
    ds_write_b64 v100, v[24:25]
    s_mov_b64 exec, -1
    s_waitcnt lgkmcnt(0)
    s_barrier
    s_cmp_lg_u32 s3, 0
    s_cbranch_scc1 L_fin
    s_lshl_b32 s58, s53, 17
    s_and_b32 s59, s88, 63
    s_lshl_b32 s59, s59, 5
    s_add_u32 s58, s58, s59
    v_lshrrev_b32 v21, 1, v0
    v_lshl_add_u32 v21, v21, 11, s58
    v_and_b32 v23, 1, v0
    v_lshl_add_u32 v21, v23, 4, v21
    s_mov_b32 s84, 65536
    buffer_load_dwordx4 v[36:39], v21, s[40:43], 0 offen sc1
    buffer_load_dwordx4 v[40:43], v21, s[40:43], s84 offen sc1
    v_and_b32 v22, 0x30, v0
    v_lshl_add_u32 v22, v23, 3, v22
    v_lshlrev_b32 v22, 4, v22
    v_add_u32 v22, 157792, v22
    ds_read_b128 v[84:87], v22
    v_cmp_eq_u32 vcc, 1, v23
    v_mov_b32 v44, 0x0c0c0400
    v_mov_b32 v22, 0x04000c0c
    v_cndmask_b32 v44, v44, v22, vcc
    s_mov_b32 s57, 262144
    s_mov_b32 s59, 0x0c0c0400
    s_add_u32 s67, s67, 1
    s_and_b32 s67, s67, 0xffff
    s_waitcnt lgkmcnt(0)
L_poll:
    s_mov_b64 exec, -1
    s_waitcnt vmcnt(0)
    v_perm_b32 v22, v37, v36, s59
    v_perm_b32 v23, v41, v40, s59
    v_cmp_ne_u32 s[80:81], s67, v22
    v_cmp_ne_u32 s[82:83], s67, v23
    s_or_b64 vcc, s[80:81], s[82:83]
    s_cbranch_scc0 L_got0
    s_sleep 2
    s_mov_b64 exec, s[80:81]
    s_cbranch_execz L_p1
    buffer_load_dwordx4 v[36:39], v21, s[40:43], 0 offen sc1
L_p1:
    s_mov_b64 exec, s[82:83]
    s_cbranch_execz L_p2
    buffer_load_dwordx4 v[40:43], v21, s[40:43], s84 offen sc1
L_p2:
    s_sub_u32 s57, s57, 1
    s_cmp_lg_u32 s57, 0
    s_cbranch_scc1 L_poll
    s_mov_b64 exec, -1
    s_waitcnt vmcnt(0)
L_got0:
    v_perm_b32 v22, v39, v38, v44
    v_perm_b32 v23, v43, v42, v44
    v_and_b32 v36, 0xffffff00, v36
    v_or_b32_dpp v22, v22, v22 quad_perm:[1,0,3,2] row_mask:0xf bank_mask:0xf
    v_or_b32_dpp v23, v23, v23 quad_perm:[1,0,3,2] row_mask:0xf bank_mask:0xf
    v_and_b32 v37, 0xffffff00, v37
    v_sub_f32_dpp v22, v22, v22 quad_perm:[2,3,0,1] row_mask:0xf bank_mask:0xf
    v_sub_f32_dpp v23, v23, v23 quad_perm:[2,3,0,1] row_mask:0xf bank_mask:0xf
    v_exp_f32 v22, v22
    v_exp_f32 v23, v23
    v_and_b32 v40, 0xffffff00, v40
    v_add_f32 v22, 1.0, v22
    v_add_f32 v23, 1.0, v23
    v_rcp_f32 v22, v22
    v_rcp_f32 v23, v23
    v_and_b32 v41, 0xffffff00, v41
    v_mul_f32 v68, v36, v22
    v_mul_f32 v69, v37, v22
    v_mul_f32 v70, v38, v22
    v_mul_f32 v71, v39, v22
    v_fmac_f32 v68, v40, v23
    v_fmac_f32 v69, v41, v23
    v_fmac_f32 v70, v42, v23
    v_fmac_f32 v71, v43, v23
L_red:
    v_permlane32_swap_b32 v68, v69
    s_nop 0
    v_permlane32_swap_b32 v70, v71
    v_add_f32 v68, v68, v69
    v_add_f32 v70, v70, v71
    s_nop 1
    v_permlane16_swap_b32 v68, v70
    v_add_f32 v68, v68, v70
    s_nop 1
    v_add_f32_dpp v68, v68, v68 row_ror:8 row_mask:0xf bank_mask:0xf
    s_nop 1
    v_add_f32_dpp v68, v68, v68 row_ror:4 row_mask:0xf bank_mask:0xf
    s_nop 1
    v_add_f32_dpp v68, v68, v68 quad_perm:[2,3,0,1] row_mask:0xf bank_mask:0xf
    v_cvt_pk_bf16_f32 v68, 0, v68
    v_mul_f32 v68, v68, v84
    v_cvt_pk_bf16_f32 v68, 0, v68
    v_add_f32 v68, v68, v85
    v_cvt_pk_bf16_f32 v68, v68, v68
    s_mov_b32 exec_lo, 0x00030003
    s_mov_b32 exec_hi, 0x00030003
    buffer_store_short v68, v87, s[44:47], 0 offen
    s_and_b32 s59, s66, 63
    s_cbranch_scc1 L_noe
    s_lshl_b32 s58, s53, 8
    s_add_u32 s58, s58, 0x180000
    s_mov_b64 exec, 1
    v_mov_b32 v21, s58
    v_mov_b32 v22, s67
    buffer_store_dword v22, v21, s[40:43], 0 offen
L_noe:
    s_mov_b64 exec, -1
L_fin:
    s_endpgm
.p2align 6
L_aux:
    v_lshrrev_b32 v101, 4, v0
    v_and_b32 v102, 15, v0
    s_bfe_u32 s68, s2, 0x30003
    v_lshlrev_b32 v21, 13, v101
    v_lshl_add_u32 v1, v102, 4, v21
    s_lshl_b32 s58, s55, 20
    v_add_u32 v110, s58, v1
    s_lshl_b32 s58, s68, 2
    v_add_u32 v22, s58, v102
    v_add_u32 v23, 16, v22
    v_and_b32 v22, 31, v22
    v_and_b32 v23, 31, v23
    v_lshl_add_u32 v22, v22, 2, v101
    v_lshl_add_u32 v23, v23, 2, v101
    v_lshlrev_b32 v22, 1, v22
    v_lshlrev_b32 v23, 1, v23
    s_lshl_b32 s58, s52, 8
    s_lshl_b32 s56, s68, 17
    s_lshl_b32 s59, s53, 10
    s_lshl_b32 s60, s55, 8
    s_add_u32 s59, s59, s60
    s_waitcnt lgkmcnt(0)
    s_mov_b32 s48, s4
    s_mov_b32 s49, s5
    s_mov_b32 s50, 4096
    s_mov_b32 s51, 0x20000
    s_add_u32 s40, s10, s58
    s_addc_u32 s41, s11, 0
    s_sub_u32 s42, 0x400000, s58
    s_mov_b32 s43, 0x20000
    buffer_load_ushort v103, v22, s[48:51], s59 offen
    buffer_load_ushort v104, v23, s[48:51], s59 offen
    s_mov_b32 s58, 0x180000
    s_add_u32 s30, s28, s58
    s_addc_u32 s31, s29, 0
    s_load_dword s76, s[30:31], 0
    s_load_dword s77, s[30:31], 256
    s_load_dword s78, s[30:31], 512
    s_load_dword s79, s[30:31], 768
    v_and_b32 v21, 1, v0
    v_lshlrev_b32 v21, 4, v21
    v_mov_b32 v22, 0xffff
    v_lshlrev_b32 v22, v21, v22
    v_bfe_u32 v21, v0, 1, 3
    v_cmp_eq_u32 vcc, 0, v21
    s_nop 1
    v_cndmask_b32 v2, 0, v22, vcc
    v_cmp_eq_u32 vcc, 1, v21
    s_nop 1
    v_cndmask_b32 v3, 0, v22, vcc
    v_cmp_eq_u32 vcc, 2, v21
    s_nop 1
    v_cndmask_b32 v4, 0, v22, vcc
    v_cmp_eq_u32 vcc, 3, v21
    s_nop 1
    v_cndmask_b32 v5, 0, v22, vcc
    v_lshrrev_b32 v21, 4, v0
    v_lshlrev_b32 v21, 8, v21
    v_and_b32 v22, 15, v0
    v_lshl_add_u32 v100, v22, 2, v21
    v_mov_b32 v10, 0xff7fffff
    v_mov_b32 v11, 0
    v_mov_b32 v24, 0
    v_mov_b32 v25, 0
    v_mov_b32 v26, 0
    v_mov_b32 v27, 0
    s_mov_b32 s61, 0x3fb8aa3b
    s_mov_b32 s62, 0x3db504f3
    s_lshl_b32 s58, s55, 3
    s_add_u32 s58, s58, 156672
    v_mov_b32 v106, s58
    ds_write_b64 v106, v[10:11]
    v_mov_b32 v111, 156720
    ds_write_b32 v111, v11 offset:20
    v_mov_b32 v111, 156752
    v_mov_b32 v109, 64
    ds_write_b32 v111, v109
    ds_write_b32 v111, v109 offset:4
    ds_write_b32 v111, v109 offset:8
    s_waitcnt vmcnt(0)
    buffer_load_dwordx4 v[128:131], v110, s[40:43], s56 offen
    s_add_u32 s56, s56, 32768
    s_and_b32 s56, s56, 0xfffff
    buffer_load_dwordx4 v[132:135], v110, s[40:43], s56 offen
    s_add_u32 s56, s56, 32768
    s_and_b32 s56, s56, 0xfffff
    buffer_load_dwordx4 v[136:139], v110, s[40:43], s56 offen
    s_add_u32 s56, s56, 32768
    s_and_b32 s56, s56, 0xfffff
    v_lshl_or_b32 v103, v103, 16, v103
    v_lshl_or_b32 v104, v104, 16, v104
    s_nop 0
    v_and_b32_dpp v28, v103, v2 row_newbcast:0 row_mask:0xf bank_mask:0xf
    v_and_b32_dpp v29, v103, v3 row_newbcast:0 row_mask:0xf bank_mask:0xf
    v_and_b32_dpp v30, v103, v4 row_newbcast:0 row_mask:0xf bank_mask:0xf
    v_and_b32_dpp v31, v103, v5 row_newbcast:0 row_mask:0xf bank_mask:0xf
    s_waitcnt vmcnt(2)
    buffer_load_dwordx4 v[140:143], v110, s[40:43], s56 offen
    s_add_u32 s56, s56, 32768
    s_and_b32 s56, s56, 0xfffff
    v_mfma_f32_16x16x32_bf16 v[24:27], v[128:131], v[28:31], v[24:27]
    v_and_b32_dpp v32, v103, v2 row_newbcast:1 row_mask:0xf bank_mask:0xf
    v_and_b32_dpp v33, v103, v3 row_newbcast:1 row_mask:0xf bank_mask:0xf
    v_and_b32_dpp v34, v103, v4 row_newbcast:1 row_mask:0xf bank_mask:0xf
    v_and_b32_dpp v35, v103, v5 row_newbcast:1 row_mask:0xf bank_mask:0xf
    s_waitcnt vmcnt(2)
    buffer_load_dwordx4 v[144:147], v110, s[40:43], s56 offen
    s_add_u32 s56, s56, 32768
    s_and_b32 s56, s56, 0xfffff
    v_mfma_f32_16x16x32_bf16 v[24:27], v[132:135], v[32:35], v[24:27]
    v_and_b32_dpp v28, v103, v2 row_newbcast:2 row_mask:0xf bank_mask:0xf
    v_and_b32_dpp v29, v103, v3 row_newbcast:2 row_mask:0xf bank_mask:0xf
    v_and_b32_dpp v30, v103, v4 row_newbcast:2 row_mask:0xf bank_mask:0xf
    v_and_b32_dpp v31, v103, v5 row_newbcast:2 row_mask:0xf bank_mask:0xf
    s_waitcnt vmcnt(2)
    buffer_load_dwordx4 v[148:151], v110, s[40:43], s56 offen
    s_add_u32 s56, s56, 32768
    s_and_b32 s56, s56, 0xfffff
    v_mfma_f32_16x16x32_bf16 v[24:27], v[136:139], v[28:31], v[24:27]
    v_and_b32_dpp v32, v103, v2 row_newbcast:3 row_mask:0xf bank_mask:0xf
    v_and_b32_dpp v33, v103, v3 row_newbcast:3 row_mask:0xf bank_mask:0xf
    v_and_b32_dpp v34, v103, v4 row_newbcast:3 row_mask:0xf bank_mask:0xf
    v_and_b32_dpp v35, v103, v5 row_newbcast:3 row_mask:0xf bank_mask:0xf
    s_waitcnt vmcnt(2)
    buffer_load_dwordx4 v[152:155], v110, s[40:43], s56 offen
    s_add_u32 s56, s56, 32768
    s_and_b32 s56, s56, 0xfffff
    v_mfma_f32_16x16x32_bf16 v[24:27], v[140:143], v[32:35], v[24:27]
    v_and_b32_dpp v28, v103, v2 row_newbcast:4 row_mask:0xf bank_mask:0xf
    v_and_b32_dpp v29, v103, v3 row_newbcast:4 row_mask:0xf bank_mask:0xf
    v_and_b32_dpp v30, v103, v4 row_newbcast:4 row_mask:0xf bank_mask:0xf
    v_and_b32_dpp v31, v103, v5 row_newbcast:4 row_mask:0xf bank_mask:0xf
    s_waitcnt vmcnt(2)
    buffer_load_dwordx4 v[156:159], v110, s[40:43], s56 offen
    s_add_u32 s56, s56, 32768
    s_and_b32 s56, s56, 0xfffff
    v_mfma_f32_16x16x32_bf16 v[24:27], v[144:147], v[28:31], v[24:27]
    v_and_b32_dpp v32, v103, v2 row_newbcast:5 row_mask:0xf bank_mask:0xf
    v_and_b32_dpp v33, v103, v3 row_newbcast:5 row_mask:0xf bank_mask:0xf
    v_and_b32_dpp v34, v103, v4 row_newbcast:5 row_mask:0xf bank_mask:0xf
    v_and_b32_dpp v35, v103, v5 row_newbcast:5 row_mask:0xf bank_mask:0xf
    s_waitcnt vmcnt(2)
    buffer_load_dwordx4 v[160:163], v110, s[40:43], s56 offen
    s_add_u32 s56, s56, 32768
    s_and_b32 s56, s56, 0xfffff
    v_mfma_f32_16x16x32_bf16 v[24:27], v[148:151], v[32:35], v[24:27]
    v_and_b32_dpp v28, v103, v2 row_newbcast:6 row_mask:0xf bank_mask:0xf
    v_and_b32_dpp v29, v103, v3 row_newbcast:6 row_mask:0xf bank_mask:0xf
    v_and_b32_dpp v30, v103, v4 row_newbcast:6 row_mask:0xf bank_mask:0xf
    v_and_b32_dpp v31, v103, v5 row_newbcast:6 row_mask:0xf bank_mask:0xf
    s_waitcnt vmcnt(2)
    buffer_load_dwordx4 v[164:167], v110, s[40:43], s56 offen
    s_add_u32 s56, s56, 32768
    s_and_b32 s56, s56, 0xfffff
    v_mfma_f32_16x16x32_bf16 v[24:27], v[152:155], v[28:31], v[24:27]
    v_and_b32_dpp v32, v103, v2 row_newbcast:7 row_mask:0xf bank_mask:0xf
    v_and_b32_dpp v33, v103, v3 row_newbcast:7 row_mask:0xf bank_mask:0xf
    v_and_b32_dpp v34, v103, v4 row_newbcast:7 row_mask:0xf bank_mask:0xf
    v_and_b32_dpp v35, v103, v5 row_newbcast:7 row_mask:0xf bank_mask:0xf
    s_waitcnt vmcnt(2)
    buffer_load_dwordx4 v[168:171], v110, s[40:43], s56 offen
    s_add_u32 s56, s56, 32768
    s_and_b32 s56, s56, 0xfffff
    v_mfma_f32_16x16x32_bf16 v[24:27], v[156:159], v[32:35], v[24:27]
    v_and_b32_dpp v28, v103, v2 row_newbcast:8 row_mask:0xf bank_mask:0xf
    v_and_b32_dpp v29, v103, v3 row_newbcast:8 row_mask:0xf bank_mask:0xf
    v_and_b32_dpp v30, v103, v4 row_newbcast:8 row_mask:0xf bank_mask:0xf
    v_and_b32_dpp v31, v103, v5 row_newbcast:8 row_mask:0xf bank_mask:0xf
    s_waitcnt vmcnt(2)
    buffer_load_dwordx4 v[172:175], v110, s[40:43], s56 offen
    s_add_u32 s56, s56, 32768
    s_and_b32 s56, s56, 0xfffff
    v_mfma_f32_16x16x32_bf16 v[24:27], v[160:163], v[28:31], v[24:27]
    v_and_b32_dpp v32, v103, v2 row_newbcast:9 row_mask:0xf bank_mask:0xf
    v_and_b32_dpp v33, v103, v3 row_newbcast:9 row_mask:0xf bank_mask:0xf
    v_and_b32_dpp v34, v103, v4 row_newbcast:9 row_mask:0xf bank_mask:0xf
    v_and_b32_dpp v35, v103, v5 row_newbcast:9 row_mask:0xf bank_mask:0xf
    s_waitcnt vmcnt(2)
    buffer_load_dwordx4 v[176:179], v110, s[40:43], s56 offen
    s_add_u32 s56, s56, 32768
    s_and_b32 s56, s56, 0xfffff
    v_mfma_f32_16x16x32_bf16 v[24:27], v[164:167], v[32:35], v[24:27]
    v_and_b32_dpp v28, v103, v2 row_newbcast:10 row_mask:0xf bank_mask:0xf
    v_and_b32_dpp v29, v103, v3 row_newbcast:10 row_mask:0xf bank_mask:0xf
    v_and_b32_dpp v30, v103, v4 row_newbcast:10 row_mask:0xf bank_mask:0xf
    v_and_b32_dpp v31, v103, v5 row_newbcast:10 row_mask:0xf bank_mask:0xf
    s_waitcnt vmcnt(2)
    buffer_load_dwordx4 v[180:183], v110, s[40:43], s56 offen
    s_add_u32 s56, s56, 32768
    s_and_b32 s56, s56, 0xfffff
    v_mfma_f32_16x16x32_bf16 v[24:27], v[168:171], v[28:31], v[24:27]
    v_and_b32_dpp v32, v103, v2 row_newbcast:11 row_mask:0xf bank_mask:0xf
    v_and_b32_dpp v33, v103, v3 row_newbcast:11 row_mask:0xf bank_mask:0xf
    v_and_b32_dpp v34, v103, v4 row_newbcast:11 row_mask:0xf bank_mask:0xf
    v_and_b32_dpp v35, v103, v5 row_newbcast:11 row_mask:0xf bank_mask:0xf
    s_waitcnt vmcnt(2)
    buffer_load_dwordx4 v[184:187], v110, s[40:43], s56 offen
    s_add_u32 s56, s56, 32768
    s_and_b32 s56, s56, 0xfffff
    v_mfma_f32_16x16x32_bf16 v[24:27], v[172:175], v[32:35], v[24:27]
    v_and_b32_dpp v28, v103, v2 row_newbcast:12 row_mask:0xf bank_mask:0xf
    v_and_b32_dpp v29, v103, v3 row_newbcast:12 row_mask:0xf bank_mask:0xf
    v_and_b32_dpp v30, v103, v4 row_newbcast:12 row_mask:0xf bank_mask:0xf
    v_and_b32_dpp v31, v103, v5 row_newbcast:12 row_mask:0xf bank_mask:0xf
    s_waitcnt vmcnt(2)
    buffer_load_dwordx4 v[188:191], v110, s[40:43], s56 offen
    s_add_u32 s56, s56, 32768
    s_and_b32 s56, s56, 0xfffff
    v_mfma_f32_16x16x32_bf16 v[24:27], v[176:179], v[28:31], v[24:27]
    v_and_b32_dpp v32, v103, v2 row_newbcast:13 row_mask:0xf bank_mask:0xf
    v_and_b32_dpp v33, v103, v3 row_newbcast:13 row_mask:0xf bank_mask:0xf
    v_and_b32_dpp v34, v103, v4 row_newbcast:13 row_mask:0xf bank_mask:0xf
    v_and_b32_dpp v35, v103, v5 row_newbcast:13 row_mask:0xf bank_mask:0xf
    s_waitcnt vmcnt(2)
    buffer_load_dwordx4 v[192:195], v110, s[40:43], s56 offen
    s_add_u32 s56, s56, 32768
    s_and_b32 s56, s56, 0xfffff
    v_mfma_f32_16x16x32_bf16 v[24:27], v[180:183], v[32:35], v[24:27]
    v_and_b32_dpp v28, v103, v2 row_newbcast:14 row_mask:0xf bank_mask:0xf
    v_and_b32_dpp v29, v103, v3 row_newbcast:14 row_mask:0xf bank_mask:0xf
    v_and_b32_dpp v30, v103, v4 row_newbcast:14 row_mask:0xf bank_mask:0xf
    v_and_b32_dpp v31, v103, v5 row_newbcast:14 row_mask:0xf bank_mask:0xf
    s_waitcnt vmcnt(2)
    buffer_load_dwordx4 v[196:199], v110, s[40:43], s56 offen
    s_add_u32 s56, s56, 32768
    s_and_b32 s56, s56, 0xfffff
    v_mfma_f32_16x16x32_bf16 v[24:27], v[184:187], v[28:31], v[24:27]
    v_and_b32_dpp v32, v103, v2 row_newbcast:15 row_mask:0xf bank_mask:0xf
    v_and_b32_dpp v33, v103, v3 row_newbcast:15 row_mask:0xf bank_mask:0xf
    v_and_b32_dpp v34, v103, v4 row_newbcast:15 row_mask:0xf bank_mask:0xf
    v_and_b32_dpp v35, v103, v5 row_newbcast:15 row_mask:0xf bank_mask:0xf
    s_waitcnt vmcnt(2)
    buffer_load_dwordx4 v[200:203], v110, s[40:43], s56 offen
    s_add_u32 s56, s56, 32768
    s_and_b32 s56, s56, 0xfffff
    v_mfma_f32_16x16x32_bf16 v[24:27], v[188:191], v[32:35], v[24:27]
    v_and_b32_dpp v28, v104, v2 row_newbcast:0 row_mask:0xf bank_mask:0xf
    v_and_b32_dpp v29, v104, v3 row_newbcast:0 row_mask:0xf bank_mask:0xf
    v_and_b32_dpp v30, v104, v4 row_newbcast:0 row_mask:0xf bank_mask:0xf
    v_and_b32_dpp v31, v104, v5 row_newbcast:0 row_mask:0xf bank_mask:0xf
    s_waitcnt vmcnt(2)
    buffer_load_dwordx4 v[204:207], v110, s[40:43], s56 offen
    s_add_u32 s56, s56, 32768
    s_and_b32 s56, s56, 0xfffff
    v_mfma_f32_16x16x32_bf16 v[24:27], v[192:195], v[28:31], v[24:27]
    v_and_b32_dpp v32, v104, v2 row_newbcast:1 row_mask:0xf bank_mask:0xf
    v_and_b32_dpp v33, v104, v3 row_newbcast:1 row_mask:0xf bank_mask:0xf
    v_and_b32_dpp v34, v104, v4 row_newbcast:1 row_mask:0xf bank_mask:0xf
    v_and_b32_dpp v35, v104, v5 row_newbcast:1 row_mask:0xf bank_mask:0xf
    s_waitcnt vmcnt(2)
    buffer_load_dwordx4 v[208:211], v110, s[40:43], s56 offen
    s_add_u32 s56, s56, 32768
    s_and_b32 s56, s56, 0xfffff
    v_mfma_f32_16x16x32_bf16 v[24:27], v[196:199], v[32:35], v[24:27]
    v_and_b32_dpp v28, v104, v2 row_newbcast:2 row_mask:0xf bank_mask:0xf
    v_and_b32_dpp v29, v104, v3 row_newbcast:2 row_mask:0xf bank_mask:0xf
    v_and_b32_dpp v30, v104, v4 row_newbcast:2 row_mask:0xf bank_mask:0xf
    v_and_b32_dpp v31, v104, v5 row_newbcast:2 row_mask:0xf bank_mask:0xf
    s_waitcnt vmcnt(2)
    buffer_load_dwordx4 v[212:215], v110, s[40:43], s56 offen
    s_add_u32 s56, s56, 32768
    s_and_b32 s56, s56, 0xfffff
    v_mfma_f32_16x16x32_bf16 v[24:27], v[200:203], v[28:31], v[24:27]
    v_and_b32_dpp v32, v104, v2 row_newbcast:3 row_mask:0xf bank_mask:0xf
    v_and_b32_dpp v33, v104, v3 row_newbcast:3 row_mask:0xf bank_mask:0xf
    v_and_b32_dpp v34, v104, v4 row_newbcast:3 row_mask:0xf bank_mask:0xf
    v_and_b32_dpp v35, v104, v5 row_newbcast:3 row_mask:0xf bank_mask:0xf
    s_waitcnt vmcnt(2)
    buffer_load_dwordx4 v[216:219], v110, s[40:43], s56 offen
    s_add_u32 s56, s56, 32768
    s_and_b32 s56, s56, 0xfffff
    v_mfma_f32_16x16x32_bf16 v[24:27], v[204:207], v[32:35], v[24:27]
    v_and_b32_dpp v28, v104, v2 row_newbcast:4 row_mask:0xf bank_mask:0xf
    v_and_b32_dpp v29, v104, v3 row_newbcast:4 row_mask:0xf bank_mask:0xf
    v_and_b32_dpp v30, v104, v4 row_newbcast:4 row_mask:0xf bank_mask:0xf
    v_and_b32_dpp v31, v104, v5 row_newbcast:4 row_mask:0xf bank_mask:0xf
    s_waitcnt vmcnt(2)
    buffer_load_dwordx4 v[220:223], v110, s[40:43], s56 offen
    s_add_u32 s56, s56, 32768
    s_and_b32 s56, s56, 0xfffff
    v_mfma_f32_16x16x32_bf16 v[24:27], v[208:211], v[28:31], v[24:27]
    v_and_b32_dpp v32, v104, v2 row_newbcast:5 row_mask:0xf bank_mask:0xf
    v_and_b32_dpp v33, v104, v3 row_newbcast:5 row_mask:0xf bank_mask:0xf
    v_and_b32_dpp v34, v104, v4 row_newbcast:5 row_mask:0xf bank_mask:0xf
    v_and_b32_dpp v35, v104, v5 row_newbcast:5 row_mask:0xf bank_mask:0xf
    s_waitcnt vmcnt(2)
    buffer_load_dwordx4 v[224:227], v110, s[40:43], s56 offen
    s_add_u32 s56, s56, 32768
    s_and_b32 s56, s56, 0xfffff
    v_mfma_f32_16x16x32_bf16 v[24:27], v[212:215], v[32:35], v[24:27]
    v_and_b32_dpp v28, v104, v2 row_newbcast:6 row_mask:0xf bank_mask:0xf
    v_and_b32_dpp v29, v104, v3 row_newbcast:6 row_mask:0xf bank_mask:0xf
    v_and_b32_dpp v30, v104, v4 row_newbcast:6 row_mask:0xf bank_mask:0xf
    v_and_b32_dpp v31, v104, v5 row_newbcast:6 row_mask:0xf bank_mask:0xf
    s_waitcnt vmcnt(2)
    buffer_load_dwordx4 v[228:231], v110, s[40:43], s56 offen
    s_add_u32 s56, s56, 32768
    s_and_b32 s56, s56, 0xfffff
    v_mfma_f32_16x16x32_bf16 v[24:27], v[216:219], v[28:31], v[24:27]
    v_and_b32_dpp v32, v104, v2 row_newbcast:7 row_mask:0xf bank_mask:0xf
    v_and_b32_dpp v33, v104, v3 row_newbcast:7 row_mask:0xf bank_mask:0xf
    v_and_b32_dpp v34, v104, v4 row_newbcast:7 row_mask:0xf bank_mask:0xf
    v_and_b32_dpp v35, v104, v5 row_newbcast:7 row_mask:0xf bank_mask:0xf
    s_waitcnt vmcnt(2)
    buffer_load_dwordx4 v[232:235], v110, s[40:43], s56 offen
    s_add_u32 s56, s56, 32768
    s_and_b32 s56, s56, 0xfffff
    v_mfma_f32_16x16x32_bf16 v[24:27], v[220:223], v[32:35], v[24:27]
    v_and_b32_dpp v28, v104, v2 row_newbcast:8 row_mask:0xf bank_mask:0xf
    v_and_b32_dpp v29, v104, v3 row_newbcast:8 row_mask:0xf bank_mask:0xf
    v_and_b32_dpp v30, v104, v4 row_newbcast:8 row_mask:0xf bank_mask:0xf
    v_and_b32_dpp v31, v104, v5 row_newbcast:8 row_mask:0xf bank_mask:0xf
    s_waitcnt vmcnt(2)
    buffer_load_dwordx4 v[236:239], v110, s[40:43], s56 offen
    s_add_u32 s56, s56, 32768
    s_and_b32 s56, s56, 0xfffff
    v_mfma_f32_16x16x32_bf16 v[24:27], v[224:227], v[28:31], v[24:27]
    v_and_b32_dpp v32, v104, v2 row_newbcast:9 row_mask:0xf bank_mask:0xf
    v_and_b32_dpp v33, v104, v3 row_newbcast:9 row_mask:0xf bank_mask:0xf
    v_and_b32_dpp v34, v104, v4 row_newbcast:9 row_mask:0xf bank_mask:0xf
    v_and_b32_dpp v35, v104, v5 row_newbcast:9 row_mask:0xf bank_mask:0xf
    s_waitcnt vmcnt(2)
    buffer_load_dwordx4 v[240:243], v110, s[40:43], s56 offen
    s_add_u32 s56, s56, 32768
    s_and_b32 s56, s56, 0xfffff
    v_mfma_f32_16x16x32_bf16 v[24:27], v[228:231], v[32:35], v[24:27]
    v_and_b32_dpp v28, v104, v2 row_newbcast:10 row_mask:0xf bank_mask:0xf
    v_and_b32_dpp v29, v104, v3 row_newbcast:10 row_mask:0xf bank_mask:0xf
    v_and_b32_dpp v30, v104, v4 row_newbcast:10 row_mask:0xf bank_mask:0xf
    v_and_b32_dpp v31, v104, v5 row_newbcast:10 row_mask:0xf bank_mask:0xf
    s_waitcnt vmcnt(2)
    buffer_load_dwordx4 v[244:247], v110, s[40:43], s56 offen
    s_add_u32 s56, s56, 32768
    s_and_b32 s56, s56, 0xfffff
    v_mfma_f32_16x16x32_bf16 v[24:27], v[232:235], v[28:31], v[24:27]
    v_and_b32_dpp v32, v104, v2 row_newbcast:11 row_mask:0xf bank_mask:0xf
    v_and_b32_dpp v33, v104, v3 row_newbcast:11 row_mask:0xf bank_mask:0xf
    v_and_b32_dpp v34, v104, v4 row_newbcast:11 row_mask:0xf bank_mask:0xf
    v_and_b32_dpp v35, v104, v5 row_newbcast:11 row_mask:0xf bank_mask:0xf
    s_waitcnt vmcnt(2)
    buffer_load_dwordx4 v[248:251], v110, s[40:43], s56 offen
    s_add_u32 s56, s56, 32768
    s_and_b32 s56, s56, 0xfffff
    v_mfma_f32_16x16x32_bf16 v[24:27], v[236:239], v[32:35], v[24:27]
    v_and_b32_dpp v28, v104, v2 row_newbcast:12 row_mask:0xf bank_mask:0xf
    v_and_b32_dpp v29, v104, v3 row_newbcast:12 row_mask:0xf bank_mask:0xf
    v_and_b32_dpp v30, v104, v4 row_newbcast:12 row_mask:0xf bank_mask:0xf
    v_and_b32_dpp v31, v104, v5 row_newbcast:12 row_mask:0xf bank_mask:0xf
    s_waitcnt vmcnt(2)
    buffer_load_dwordx4 v[252:255], v110, s[40:43], s56 offen
    v_mfma_f32_16x16x32_bf16 v[24:27], v[240:243], v[28:31], v[24:27]
    v_and_b32_dpp v32, v104, v2 row_newbcast:13 row_mask:0xf bank_mask:0xf
    v_and_b32_dpp v33, v104, v3 row_newbcast:13 row_mask:0xf bank_mask:0xf
    v_and_b32_dpp v34, v104, v4 row_newbcast:13 row_mask:0xf bank_mask:0xf
    v_and_b32_dpp v35, v104, v5 row_newbcast:13 row_mask:0xf bank_mask:0xf
    s_waitcnt vmcnt(2)
    s_nop 0
    v_mfma_f32_16x16x32_bf16 v[24:27], v[244:247], v[32:35], v[24:27]
    v_and_b32_dpp v28, v104, v2 row_newbcast:14 row_mask:0xf bank_mask:0xf
    v_and_b32_dpp v29, v104, v3 row_newbcast:14 row_mask:0xf bank_mask:0xf
    v_and_b32_dpp v30, v104, v4 row_newbcast:14 row_mask:0xf bank_mask:0xf
    v_and_b32_dpp v31, v104, v5 row_newbcast:14 row_mask:0xf bank_mask:0xf
    s_waitcnt vmcnt(1)
    s_nop 0
    v_mfma_f32_16x16x32_bf16 v[24:27], v[248:251], v[28:31], v[24:27]
    v_and_b32_dpp v32, v104, v2 row_newbcast:15 row_mask:0xf bank_mask:0xf
    v_and_b32_dpp v33, v104, v3 row_newbcast:15 row_mask:0xf bank_mask:0xf
    v_and_b32_dpp v34, v104, v4 row_newbcast:15 row_mask:0xf bank_mask:0xf
    v_and_b32_dpp v35, v104, v5 row_newbcast:15 row_mask:0xf bank_mask:0xf
    s_waitcnt vmcnt(0)
    s_nop 0
    v_mfma_f32_16x16x32_bf16 v[24:27], v[252:255], v[32:35], v[24:27]
    s_lshl_b32 s58, s55, 10
    s_add_u32 s58, s58, 131072
    v_add_u32 v21, s58, v100
    s_nop 5
    ds_write2_b32 v21, v24, v25 offset0:0 offset1:16
    ds_write2_b32 v21, v26, v27 offset0:32 offset1:48
    s_waitcnt lgkmcnt(0)
    s_barrier
    s_add_u32 s76, s76, 1
    s_and_b32 s76, s76, 0xffff
    s_add_u32 s77, s77, 1
    s_and_b32 s77, s77, 0xffff
    s_add_u32 s78, s78, 1
    s_and_b32 s78, s78, 0xffff
    s_add_u32 s79, s79, 1
    s_and_b32 s79, s79, 0xffff
    s_mov_b32 s67, s76
    s_cmp_eq_u32 s53, 1
    s_cmov_b32 s67, s77
    s_cmp_eq_u32 s53, 2
    s_cmov_b32 s67, s78
    s_cmp_eq_u32 s53, 3
    s_cmov_b32 s67, s79
    s_mov_b32 s44, s28
    s_mov_b32 s45, s29
    s_mov_b32 s46, 2097152
    s_mov_b32 s47, 0x20000
    v_and_b32 v21, 15, v0
    v_lshlrev_b32 v21, 6, v21
    v_add_u32 v21, 131072, v21
    ds_read_b128 v[68:71], v21 offset:0
    ds_read_b128 v[72:75], v21 offset:16
    ds_read_b128 v[76:79], v21 offset:1024
    ds_read_b128 v[80:83], v21 offset:1040
    ds_read_b128 v[84:87], v21 offset:2048
    ds_read_b128 v[88:91], v21 offset:2064
    ds_read_b128 v[92:95], v21 offset:3072
    ds_read_b128 v[96:99], v21 offset:3088
    s_waitcnt lgkmcnt(4)
    v_add_f32 v68, v68, v76
    v_add_f32 v69, v69, v77
    v_add_f32 v70, v70, v78
    v_add_f32 v71, v71, v79
    v_add_f32 v72, v72, v80
    v_add_f32 v73, v73, v81
    v_add_f32 v74, v74, v82
    v_add_f32 v75, v75, v83
    s_waitcnt lgkmcnt(0)
    v_add_f32 v84, v84, v92
    v_add_f32 v85, v85, v93
    v_add_f32 v86, v86, v94
    v_add_f32 v87, v87, v95
    v_add_f32 v88, v88, v96
    v_add_f32 v89, v89, v97
    v_add_f32 v90, v90, v98
    v_add_f32 v91, v91, v99
    v_add_f32 v68, v68, v84
    v_add_f32 v69, v69, v85
    v_add_f32 v70, v70, v86
    v_add_f32 v71, v71, v87
    v_add_f32 v72, v72, v88
    v_add_f32 v73, v73, v89
    v_add_f32 v74, v74, v90
    v_add_f32 v75, v75, v91
    v_cvt_pk_bf16_f32 v6, v68, v69
    v_cvt_pk_bf16_f32 v7, v70, v71
    v_cvt_pk_bf16_f32 v8, v72, v73
    v_cvt_pk_bf16_f32 v9, v74, v75
    v_bfe_u32 v21, v0, 2, 1
    v_bfe_u32 v22, v0, 3, 1
    v_lshl_add_u32 v21, v21, 1, v22
    v_lshrrev_b32 v22, 4, v0
    v_mul_u32_u24 v22, 1088, v22
    v_lshl_add_u32 v21, v21, 2, v22
    s_mul_i32 s59, s55, 4352
    s_add_u32 s59, s59, 139264
    v_add_u32 v103, s59, v21
    s_lshl_b32 s58, s55, 12
    v_lshl_add_u32 v105, v0, 4, s58
    s_mov_b32 s57, 4
L_zloop:
    s_waitcnt lgkmcnt(0)
    ds_read_b128 v[36:39], v105 offset:0
    ds_read_b128 v[40:43], v105 offset:2048
    ds_read_b128 v[44:47], v105 offset:1024
    ds_read_b128 v[48:51], v105 offset:3072
    ds_read_b128 v[52:55], v105 offset:16384
    ds_read_b128 v[56:59], v105 offset:18432
    ds_read_b128 v[60:63], v105 offset:17408
    ds_read_b128 v[64:67], v105 offset:19456
    s_waitcnt lgkmcnt(7)
    v_dot2_f32_bf16 v12, v36, v6, 0
    v_dot2_f32_bf16 v12, v37, v7, v12
    v_dot2_f32_bf16 v12, v38, v8, v12
    v_dot2_f32_bf16 v12, v39, v9, v12
    s_waitcnt lgkmcnt(6)
    v_dot2_f32_bf16 v13, v40, v6, 0
    v_dot2_f32_bf16 v13, v41, v7, v13
    v_dot2_f32_bf16 v13, v42, v8, v13
    v_dot2_f32_bf16 v13, v43, v9, v13
    v_add_f32_dpp v16, v12, v12 row_ror:8 row_mask:0xf bank_mask:0x3
    s_waitcnt lgkmcnt(5)
    v_dot2_f32_bf16 v14, v44, v6, 0
    v_dot2_f32_bf16 v14, v45, v7, v14
    v_dot2_f32_bf16 v14, v46, v8, v14
    v_dot2_f32_bf16 v14, v47, v9, v14
    v_add_f32_dpp v16, v13, v13 row_ror:8 row_mask:0xf bank_mask:0xc
    s_waitcnt lgkmcnt(4)
    v_dot2_f32_bf16 v15, v48, v6, 0
    v_dot2_f32_bf16 v15, v49, v7, v15
    v_dot2_f32_bf16 v15, v50, v8, v15
    v_dot2_f32_bf16 v15, v51, v9, v15
    v_add_f32_dpp v17, v14, v14 row_ror:8 row_mask:0xf bank_mask:0x3
    v_add_f32_dpp v18, v16, v16 row_half_mirror row_mask:0xf bank_mask:0x5
    s_nop 0
    v_add_f32_dpp v17, v15, v15 row_ror:8 row_mask:0xf bank_mask:0xc
    s_nop 1
    v_add_f32_dpp v18, v17, v17 row_half_mirror row_mask:0xf bank_mask:0xa
    s_nop 1
    v_add_f32_dpp v18, v18, v18 quad_perm:[1,0,3,2] row_mask:0xf bank_mask:0xf
    s_nop 1
    v_add_f32_dpp v18, v18, v18 quad_perm:[2,3,0,1] row_mask:0xf bank_mask:0xf
    v_cvt_pk_bf16_f32 v18, 0, v18
    v_mul_f32 v18, s62, v18
    v_cvt_pk_bf16_f32 v18, 0, v18
    ds_write_b32 v103, v18 offset:0
    v_max_f32 v10, v10, v18
    s_waitcnt lgkmcnt(4)
    v_dot2_f32_bf16 v12, v52, v6, 0
    v_dot2_f32_bf16 v12, v53, v7, v12
    v_dot2_f32_bf16 v12, v54, v8, v12
    v_dot2_f32_bf16 v12, v55, v9, v12
    s_waitcnt lgkmcnt(3)
    v_dot2_f32_bf16 v13, v56, v6, 0
    v_dot2_f32_bf16 v13, v57, v7, v13
    v_dot2_f32_bf16 v13, v58, v8, v13
    v_dot2_f32_bf16 v13, v59, v9, v13
    v_add_f32_dpp v16, v12, v12 row_ror:8 row_mask:0xf bank_mask:0x3
    s_waitcnt lgkmcnt(2)
    v_dot2_f32_bf16 v14, v60, v6, 0
    v_dot2_f32_bf16 v14, v61, v7, v14
    v_dot2_f32_bf16 v14, v62, v8, v14
    v_dot2_f32_bf16 v14, v63, v9, v14
    v_add_f32_dpp v16, v13, v13 row_ror:8 row_mask:0xf bank_mask:0xc
    s_waitcnt lgkmcnt(1)
    v_dot2_f32_bf16 v15, v64, v6, 0
    v_dot2_f32_bf16 v15, v65, v7, v15
    v_dot2_f32_bf16 v15, v66, v8, v15
    v_dot2_f32_bf16 v15, v67, v9, v15
    v_add_f32_dpp v17, v14, v14 row_ror:8 row_mask:0xf bank_mask:0x3
    v_add_f32_dpp v18, v16, v16 row_half_mirror row_mask:0xf bank_mask:0x5
    s_nop 0
    v_add_f32_dpp v17, v15, v15 row_ror:8 row_mask:0xf bank_mask:0xc
    s_nop 1
    v_add_f32_dpp v18, v17, v17 row_half_mirror row_mask:0xf bank_mask:0xa
    s_nop 1
    v_add_f32_dpp v18, v18, v18 quad_perm:[1,0,3,2] row_mask:0xf bank_mask:0xf
    s_nop 1
    v_add_f32_dpp v18, v18, v18 quad_perm:[2,3,0,1] row_mask:0xf bank_mask:0xf
    v_cvt_pk_bf16_f32 v18, 0, v18
    v_mul_f32 v18, s62, v18
    v_cvt_pk_bf16_f32 v18, 0, v18
    ds_write_b32 v103, v18 offset:16
    v_max_f32 v10, v10, v18
    v_add_u32 v105, 0x8000, v105
    v_add_u32 v103, 32, v103
    s_sub_u32 s57, s57, 1
    s_cmp_lg_u32 s57, 0
    s_cbranch_scc1 L_zloop
    s_nop 1
    v_max_f32_dpp v10, v10, v10 row_ror:8 row_mask:0xf bank_mask:0xf
    s_nop 1
    v_max_f32_dpp v10, v10, v10 row_ror:4 row_mask:0xf bank_mask:0xf
    s_nop 1
    v_max_f32_dpp v10, v10, v10 row_bcast:15 row_mask:0xa bank_mask:0xf
    s_nop 1
    v_max_f32_dpp v10, v10, v10 row_bcast:31 row_mask:0xc bank_mask:0xf
    s_nop 0
    v_readlane_b32 s60, v10, 63
    s_nop 1
    v_mov_b32 v10, s60
    v_mov_b32 v11, 1
    ds_write_b64 v106, v[10:11]
    s_lshl_b32 s58, s52, 17
    s_add_u32 s40, s12, s58
    s_addc_u32 s41, s13, 0
    s_mov_b32 s42, 131072
    s_mov_b32 s43, 0x20000
    s_lshl_b32 s59, s55, 8
    v_lshl_add_u32 v1, v102, 4, s59
    v_lshl_add_u32 v1, v101, 11, v1
    s_mov_b32 s56, 0
    buffer_load_dwordx4 v[128:131], v1, s[40:43], s56 offen offset:0 nt
    s_mov_b32 s56, 8192
    buffer_load_dwordx4 v[132:135], v1, s[40:43], s56 offen offset:0 nt
    s_mov_b32 s56, 16384
    s_waitcnt vmcnt(1)
    buffer_load_dwordx4 v[136:139], v1, s[40:43], s56 offen offset:0 nt
    s_mov_b32 s56, 24576
    s_waitcnt vmcnt(1)
    buffer_load_dwordx4 v[140:143], v1, s[40:43], s56 offen offset:0 nt
    s_mov_b32 s56, 0
    s_waitcnt vmcnt(1)
    buffer_load_dwordx4 v[144:147], v1, s[40:43], s56 offen offset:1024 nt
    s_mov_b32 s56, 8192
    s_waitcnt vmcnt(1)
    buffer_load_dwordx4 v[148:151], v1, s[40:43], s56 offen offset:1024 nt
    s_mov_b32 s56, 16384
    s_waitcnt vmcnt(1)
    buffer_load_dwordx4 v[152:155], v1, s[40:43], s56 offen offset:1024 nt
    s_mov_b32 s56, 24576
    s_waitcnt vmcnt(1)
    buffer_load_dwordx4 v[156:159], v1, s[40:43], s56 offen offset:1024 nt
    s_mov_b32 s56, 32768
    s_waitcnt vmcnt(1)
    buffer_load_dwordx4 v[160:163], v1, s[40:43], s56 offen offset:0 nt
    s_mov_b32 s56, 40960
    s_waitcnt vmcnt(1)
    buffer_load_dwordx4 v[164:167], v1, s[40:43], s56 offen offset:0 nt
    s_mov_b32 s56, 49152
    s_waitcnt vmcnt(1)
    buffer_load_dwordx4 v[168:171], v1, s[40:43], s56 offen offset:0 nt
    s_mov_b32 s56, 57344
    s_waitcnt vmcnt(1)
    buffer_load_dwordx4 v[172:175], v1, s[40:43], s56 offen offset:0 nt
    s_mov_b32 s56, 32768
    s_waitcnt vmcnt(1)
    buffer_load_dwordx4 v[176:179], v1, s[40:43], s56 offen offset:1024 nt
    s_mov_b32 s56, 40960
    s_waitcnt vmcnt(1)
    buffer_load_dwordx4 v[180:183], v1, s[40:43], s56 offen offset:1024 nt
    s_mov_b32 s56, 49152
    s_waitcnt vmcnt(1)
    buffer_load_dwordx4 v[184:187], v1, s[40:43], s56 offen offset:1024 nt
    s_mov_b32 s56, 57344
    s_waitcnt vmcnt(1)
    buffer_load_dwordx4 v[188:191], v1, s[40:43], s56 offen offset:1024 nt
    s_mov_b32 s56, 65536
    s_waitcnt vmcnt(1)
    buffer_load_dwordx4 v[192:195], v1, s[40:43], s56 offen offset:0 nt
    s_mov_b32 s56, 73728
    s_waitcnt vmcnt(1)
    buffer_load_dwordx4 v[196:199], v1, s[40:43], s56 offen offset:0 nt
    s_mov_b32 s56, 81920
    s_waitcnt vmcnt(1)
    buffer_load_dwordx4 v[200:203], v1, s[40:43], s56 offen offset:0 nt
    s_mov_b32 s56, 90112
    s_waitcnt vmcnt(1)
    buffer_load_dwordx4 v[204:207], v1, s[40:43], s56 offen offset:0 nt
    s_mov_b32 s56, 65536
    s_waitcnt vmcnt(1)
    buffer_load_dwordx4 v[208:211], v1, s[40:43], s56 offen offset:1024 nt
    s_mov_b32 s56, 73728
    s_waitcnt vmcnt(1)
    buffer_load_dwordx4 v[212:215], v1, s[40:43], s56 offen offset:1024 nt
    s_mov_b32 s56, 81920
    s_waitcnt vmcnt(1)
    buffer_load_dwordx4 v[216:219], v1, s[40:43], s56 offen offset:1024 nt
    s_mov_b32 s56, 90112
    s_waitcnt vmcnt(1)
    buffer_load_dwordx4 v[220:223], v1, s[40:43], s56 offen offset:1024 nt
    s_mov_b32 s56, 98304
    s_waitcnt vmcnt(1)
    buffer_load_dwordx4 v[224:227], v1, s[40:43], s56 offen offset:0 nt
    s_mov_b32 s56, 106496
    s_waitcnt vmcnt(1)
    buffer_load_dwordx4 v[228:231], v1, s[40:43], s56 offen offset:0 nt
    s_mov_b32 s56, 114688
    s_waitcnt vmcnt(1)
    buffer_load_dwordx4 v[232:235], v1, s[40:43], s56 offen offset:0 nt
    s_mov_b32 s56, 122880
    s_waitcnt vmcnt(1)
    buffer_load_dwordx4 v[236:239], v1, s[40:43], s56 offen offset:0 nt
    s_mov_b32 s56, 98304
    s_waitcnt vmcnt(1)
    buffer_load_dwordx4 v[240:243], v1, s[40:43], s56 offen offset:1024 nt
    s_mov_b32 s56, 106496
    s_waitcnt vmcnt(1)
    buffer_load_dwordx4 v[244:247], v1, s[40:43], s56 offen offset:1024 nt
    s_mov_b32 s56, 114688
    s_waitcnt vmcnt(1)
    buffer_load_dwordx4 v[248:251], v1, s[40:43], s56 offen offset:1024 nt
    s_mov_b32 s56, 122880
    s_waitcnt vmcnt(1)
    buffer_load_dwordx4 v[252:255], v1, s[40:43], s56 offen offset:1024 nt
    s_mov_b32 s63, 0x05040100
    s_mov_b32 s64, 0x07060302
    v_mov_b32 v28, v101
    v_mov_b32 v29, v102
    s_waitcnt vmcnt(0)
    v_perm_b32 v96, v132, v128, s63
    v_perm_b32 v97, v140, v136, s63
    v_perm_b32 v98, v148, v144, s63
    v_perm_b32 v99, v156, v152, s63
    v_perm_b32 v100, v132, v128, s64
    v_perm_b32 v101, v140, v136, s64
    v_perm_b32 v102, v148, v144, s64
    v_perm_b32 v103, v156, v152, s64
    v_perm_b32 v104, v133, v129, s63
    v_perm_b32 v105, v141, v137, s63
    v_perm_b32 v106, v149, v145, s63
    v_perm_b32 v107, v157, v153, s63
    v_perm_b32 v108, v133, v129, s64
    v_perm_b32 v109, v141, v137, s64
    v_perm_b32 v110, v149, v145, s64
    v_perm_b32 v111, v157, v153, s64
    v_perm_b32 v112, v134, v130, s63
    v_perm_b32 v113, v142, v138, s63
    v_perm_b32 v114, v150, v146, s63
    v_perm_b32 v115, v158, v154, s63
    v_perm_b32 v116, v134, v130, s64
    v_perm_b32 v117, v142, v138, s64
    v_perm_b32 v118, v150, v146, s64
    v_perm_b32 v119, v158, v154, s64
    v_perm_b32 v120, v135, v131, s63
    v_perm_b32 v121, v143, v139, s63
    v_perm_b32 v122, v151, v147, s63
    v_perm_b32 v123, v159, v155, s63
    v_perm_b32 v124, v135, v131, s64
    v_perm_b32 v125, v143, v139, s64
    v_perm_b32 v126, v151, v147, s64
    v_perm_b32 v127, v159, v155, s64
    v_perm_b32 v128, v164, v160, s63
    v_perm_b32 v129, v172, v168, s63
    v_perm_b32 v130, v180, v176, s63
    v_perm_b32 v131, v188, v184, s63
    v_perm_b32 v132, v164, v160, s64
    v_perm_b32 v133, v172, v168, s64
    v_perm_b32 v134, v180, v176, s64
    v_perm_b32 v135, v188, v184, s64
    v_perm_b32 v136, v165, v161, s63
    v_perm_b32 v137, v173, v169, s63
    v_perm_b32 v138, v181, v177, s63
    v_perm_b32 v139, v189, v185, s63
    v_perm_b32 v140, v165, v161, s64
    v_perm_b32 v141, v173, v169, s64
    v_perm_b32 v142, v181, v177, s64
    v_perm_b32 v143, v189, v185, s64
    v_perm_b32 v144, v166, v162, s63
    v_perm_b32 v145, v174, v170, s63
    v_perm_b32 v146, v182, v178, s63
    v_perm_b32 v147, v190, v186, s63
    v_perm_b32 v148, v166, v162, s64
    v_perm_b32 v149, v174, v170, s64
    v_perm_b32 v150, v182, v178, s64
    v_perm_b32 v151, v190, v186, s64
    v_perm_b32 v152, v167, v163, s63
    v_perm_b32 v153, v175, v171, s63
    v_perm_b32 v154, v183, v179, s63
    v_perm_b32 v155, v191, v187, s63
    v_perm_b32 v156, v167, v163, s64
    v_perm_b32 v157, v175, v171, s64
    v_perm_b32 v158, v183, v179, s64
    v_perm_b32 v159, v191, v187, s64
    v_perm_b32 v160, v196, v192, s63
    v_perm_b32 v161, v204, v200, s63
    v_perm_b32 v162, v212, v208, s63
    v_perm_b32 v163, v220, v216, s63
    v_perm_b32 v164, v196, v192, s64
    v_perm_b32 v165, v204, v200, s64
    v_perm_b32 v166, v212, v208, s64
    v_perm_b32 v167, v220, v216, s64
    v_perm_b32 v168, v197, v193, s63
    v_perm_b32 v169, v205, v201, s63
    v_perm_b32 v170, v213, v209, s63
    v_perm_b32 v171, v221, v217, s63
    v_perm_b32 v172, v197, v193, s64
    v_perm_b32 v173, v205, v201, s64
    v_perm_b32 v174, v213, v209, s64
    v_perm_b32 v175, v221, v217, s64
    v_perm_b32 v176, v198, v194, s63
    v_perm_b32 v177, v206, v202, s63
    v_perm_b32 v178, v214, v210, s63
    v_perm_b32 v179, v222, v218, s63
    v_perm_b32 v180, v198, v194, s64
    v_perm_b32 v181, v206, v202, s64
    v_perm_b32 v182, v214, v210, s64
    v_perm_b32 v183, v222, v218, s64
    v_perm_b32 v184, v199, v195, s63
    v_perm_b32 v185, v207, v203, s63
    v_perm_b32 v186, v215, v211, s63
    v_perm_b32 v187, v223, v219, s63
    v_perm_b32 v188, v199, v195, s64
    v_perm_b32 v189, v207, v203, s64
    v_perm_b32 v190, v215, v211, s64
    v_perm_b32 v191, v223, v219, s64
    v_perm_b32 v192, v228, v224, s63
    v_perm_b32 v193, v236, v232, s63
    v_perm_b32 v194, v244, v240, s63
    v_perm_b32 v195, v252, v248, s63
    v_perm_b32 v196, v228, v224, s64
    v_perm_b32 v197, v236, v232, s64
    v_perm_b32 v198, v244, v240, s64
    v_perm_b32 v199, v252, v248, s64
    v_perm_b32 v200, v229, v225, s63
    v_perm_b32 v201, v237, v233, s63
    v_perm_b32 v202, v245, v241, s63
    v_perm_b32 v203, v253, v249, s63
    v_perm_b32 v204, v229, v225, s64
    v_perm_b32 v205, v237, v233, s64
    v_perm_b32 v206, v245, v241, s64
    v_perm_b32 v207, v253, v249, s64
    v_perm_b32 v208, v230, v226, s63
    v_perm_b32 v209, v238, v234, s63
    v_perm_b32 v210, v246, v242, s63
    v_perm_b32 v211, v254, v250, s63
    v_perm_b32 v212, v230, v226, s64
    v_perm_b32 v213, v238, v234, s64
    v_perm_b32 v214, v246, v242, s64
    v_perm_b32 v215, v254, v250, s64
    v_perm_b32 v216, v231, v227, s63
    v_perm_b32 v217, v239, v235, s63
    v_perm_b32 v218, v247, v243, s63
    v_perm_b32 v219, v255, v251, s63
    v_perm_b32 v220, v231, v227, s64
    v_perm_b32 v221, v239, v235, s64
    v_perm_b32 v222, v247, v243, s64
    v_perm_b32 v223, v255, v251, s64
    s_cmp_eq_u32 s55, 0
    s_cbranch_scc1 L_wipe
    s_cmp_eq_u32 s55, 1
    s_cbranch_scc1 L_ffn
    s_cmp_eq_u32 s55, 2
    s_cbranch_scc1 L_gate
    s_branch L_sum
.p2align 10
L_join:
    v_lshrrev_b32 v21, 2, v0
    v_lshlrev_b32 v21, 6, v21
    v_and_b32 v22, 3, v0
    v_lshl_add_u32 v40, v22, 3, v21
    v_add_u32 v40, 135168, v40
    v_mov_b32 v41, 156720
    s_lshl_b32 s58, s55, 8
    s_add_u32 s58, s58, 156768
    v_lshl_add_u32 v42, v0, 2, s58
    v_lshl_add_u32 v43, v28, 4, s58
    v_and_b32 v21, 3, v29
    v_mul_u32_u24 v21, 272, v21
    v_lshl_add_u32 v43, v28, 4, v21
    v_add_u32 v43, 135168, v43
    s_lshl_b32 s58, s66, 11
    s_lshl_b32 s59, s55, 9
    s_add_u32 s58, s58, s59
    v_lshl_add_u32 v44, v29, 5, s58
    v_lshl_add_u32 v44, v28, 4, v44
    v_lshlrev_b32 v45, 4, v28
    s_mov_b32 s32, s28
    s_mov_b32 s33, s29
    s_mov_b32 s34, 1048576
    s_mov_b32 s35, 0x20000
    v_mov_b32 v80, s67
    v_lshrrev_b32 v81, 8, v80
    s_mov_b32 s68, 0xffff0000
    s_mov_b32 s69, 0
    s_mov_b32 s60, 0xffffff00
    s_waitcnt vmcnt(0) lgkmcnt(0)
    s_barrier
    ds_read_b128 v[48:51], v43 offset:0
    ds_read_b128 v[52:55], v43 offset:64
    ds_read_b128 v[56:59], v43 offset:128
    ds_read_b128 v[60:63], v43 offset:192
    ds_read_b32 v22, v41 offset:16
    s_waitcnt lgkmcnt(4)
    v_mfma_f32_16x16x32_bf16 v[224:227], v[48:51], v[96:99], 0
    s_waitcnt lgkmcnt(3)
    v_mfma_f32_16x16x32_bf16 v[224:227], v[52:55], v[128:131], v[224:227]
    s_waitcnt lgkmcnt(2)
    v_mfma_f32_16x16x32_bf16 v[224:227], v[56:59], v[160:163], v[224:227]
    s_waitcnt lgkmcnt(1)
    v_mfma_f32_16x16x32_bf16 v[224:227], v[60:63], v[192:195], v[224:227]
    v_mfma_f32_16x16x32_bf16 v[240:243], v[48:51], v[112:115], 0
    s_waitcnt lgkmcnt(0)
    v_lshrrev_b32 v82, v45, v22
    v_mfma_f32_16x16x32_bf16 v[240:243], v[52:55], v[144:147], v[240:243]
    v_lshrrev_b32 v83, 8, v82
    v_mfma_f32_16x16x32_bf16 v[240:243], v[56:59], v[176:179], v[240:243]
    v_mfma_f32_16x16x32_bf16 v[240:243], v[60:63], v[208:211], v[240:243]
    v_mfma_f32_16x16x32_bf16 v[228:231], v[48:51], v[100:103], 0
    v_mfma_f32_16x16x32_bf16 v[228:231], v[52:55], v[132:135], v[228:231]
    v_mfma_f32_16x16x32_bf16 v[228:231], v[56:59], v[164:167], v[228:231]
    v_mfma_f32_16x16x32_bf16 v[228:231], v[60:63], v[196:199], v[228:231]
    v_mfma_f32_16x16x32_bf16 v[244:247], v[48:51], v[116:119], 0
    v_add_f32 v224, v224, v225
    v_add_f32 v226, v226, v227
    v_mfma_f32_16x16x32_bf16 v[244:247], v[52:55], v[148:151], v[244:247]
    v_add_f32 v224, v224, v226
    v_mfma_f32_16x16x32_bf16 v[244:247], v[56:59], v[180:183], v[244:247]
    v_mfma_f32_16x16x32_bf16 v[244:247], v[60:63], v[212:215], v[244:247]
    v_mfma_f32_16x16x32_bf16 v[232:235], v[48:51], v[104:107], 0
    v_add_f32 v240, v240, v241
    v_add_f32 v242, v242, v243
    v_mfma_f32_16x16x32_bf16 v[232:235], v[52:55], v[136:139], v[232:235]
    v_add_f32 v240, v240, v242
    v_cndmask_b32 v64, v224, v240, s[68:69]
    v_mfma_f32_16x16x32_bf16 v[232:235], v[56:59], v[168:171], v[232:235]
    v_bfi_b32 v64, s60, v64, v80
    v_mfma_f32_16x16x32_bf16 v[232:235], v[60:63], v[200:203], v[232:235]
    v_mfma_f32_16x16x32_bf16 v[248:251], v[48:51], v[120:123], 0
    v_add_f32 v228, v228, v229
    v_add_f32 v230, v230, v231
    v_mfma_f32_16x16x32_bf16 v[248:251], v[52:55], v[152:155], v[248:251]
    v_add_f32 v228, v228, v230
    v_mfma_f32_16x16x32_bf16 v[248:251], v[56:59], v[184:187], v[248:251]
    v_mfma_f32_16x16x32_bf16 v[248:251], v[60:63], v[216:219], v[248:251]
    v_mfma_f32_16x16x32_bf16 v[236:239], v[48:51], v[108:111], 0
    v_add_f32 v244, v244, v245
    v_add_f32 v246, v246, v247
    v_mfma_f32_16x16x32_bf16 v[236:239], v[52:55], v[140:143], v[236:239]
    v_add_f32 v244, v244, v246
    v_cndmask_b32 v65, v228, v244, s[68:69]
    v_mfma_f32_16x16x32_bf16 v[236:239], v[56:59], v[172:175], v[236:239]
    v_bfi_b32 v65, s60, v65, v81
    v_mfma_f32_16x16x32_bf16 v[236:239], v[60:63], v[204:207], v[236:239]
    v_mfma_f32_16x16x32_bf16 v[252:255], v[48:51], v[124:127], 0
    v_add_f32 v232, v232, v233
    v_add_f32 v234, v234, v235
    v_mfma_f32_16x16x32_bf16 v[252:255], v[52:55], v[156:159], v[252:255]
    v_add_f32 v232, v232, v234
    v_add_f32 v248, v248, v249
    v_mfma_f32_16x16x32_bf16 v[252:255], v[56:59], v[188:191], v[252:255]
    v_add_f32 v250, v250, v251
    v_add_f32 v248, v248, v250
    v_mfma_f32_16x16x32_bf16 v[252:255], v[60:63], v[220:223], v[252:255]
    v_cndmask_b32 v66, v232, v248, s[68:69]
    v_bfi_b32 v66, s60, v66, v82
    v_add_f32 v236, v236, v237
    v_add_f32 v238, v238, v239
    v_add_f32 v236, v236, v238
    s_nop 2
    v_add_f32 v252, v252, v253
    v_add_f32 v254, v254, v255
    v_add_f32 v252, v252, v254
    v_cndmask_b32 v67, v236, v252, s[68:69]
    v_bfi_b32 v67, s60, v67, v83
    s_mov_b32 exec_hi, 0
    buffer_store_dwordx4 v[64:67], v44, s[32:35], 0 offen sc1
    s_endpgm
L_sum:
    v_and_b32 v21, 3, v0
    v_lshlrev_b32 v21, 8, v21
    v_add_u32 v21, 158816, v21
    s_mov_b32 s57, 262144
    s_mov_b32 s59, 2097152
L_sw:
    ds_read_b32 v22, v21
    s_waitcnt lgkmcnt(0)
    v_cmp_gt_u32 vcc, s59, v22
    s_cbranch_vccz L_sgo
    s_sleep 32
    s_sub_u32 s57, s57, 1
    s_cmp_lg_u32 s57, 0
    s_cbranch_scc1 L_sw
L_sgo:
    v_mov_b32 v21, 156704
    ds_read_b128 v[4:7], v21
    v_mul_u32_u24 v22, 1088, v28
    v_lshl_add_u32 v22, v29, 6, v22
    v_add_u32 v22, 139264, v22
    ds_read_b128 v[32:35], v22 offset:0
    ds_read_b128 v[36:39], v22 offset:16
    ds_read_b128 v[40:43], v22 offset:32
    ds_read_b128 v[44:47], v22 offset:48
    ds_read_b128 v[48:51], v22 offset:4352
    ds_read_b128 v[52:55], v22 offset:4368
    ds_read_b128 v[56:59], v22 offset:4384
    ds_read_b128 v[60:63], v22 offset:4400
    s_waitcnt lgkmcnt(0)
    ds_read_b128 v[64:67], v22 offset:8704
    ds_read_b128 v[68:71], v22 offset:8720
    ds_read_b128 v[72:75], v22 offset:8736
    ds_read_b128 v[76:79], v22 offset:8752
    ds_read_b128 v[80:83], v22 offset:13056
    ds_read_b128 v[84:87], v22 offset:13072
    ds_read_b128 v[88:91], v22 offset:13088
    ds_read_b128 v[92:95], v22 offset:13104
    v_max3_f32 v8, v4, v5, v6
    v_max_f32 v8, v8, v7
    v_mov_b32 v9, 0
    s_waitcnt lgkmcnt(0)
    v_fma_f32 v32, v32, s61, -v8
    v_fma_f32 v33, v33, s61, -v8
    v_fma_f32 v34, v34, s61, -v8
    v_fma_f32 v35, v35, s61, -v8
    v_fma_f32 v36, v36, s61, -v8
    v_fma_f32 v37, v37, s61, -v8
    v_fma_f32 v38, v38, s61, -v8
    v_fma_f32 v39, v39, s61, -v8
    v_fma_f32 v40, v40, s61, -v8
    v_fma_f32 v41, v41, s61, -v8
    v_fma_f32 v42, v42, s61, -v8
    v_fma_f32 v43, v43, s61, -v8
    v_fma_f32 v44, v44, s61, -v8
    v_fma_f32 v45, v45, s61, -v8
    v_fma_f32 v46, v46, s61, -v8
    v_fma_f32 v47, v47, s61, -v8
    v_fma_f32 v48, v48, s61, -v8
    v_fma_f32 v49, v49, s61, -v8
    v_fma_f32 v50, v50, s61, -v8
    v_fma_f32 v51, v51, s61, -v8
    v_fma_f32 v52, v52, s61, -v8
    v_fma_f32 v53, v53, s61, -v8
    v_fma_f32 v54, v54, s61, -v8
    v_fma_f32 v55, v55, s61, -v8
    v_fma_f32 v56, v56, s61, -v8
    v_fma_f32 v57, v57, s61, -v8
    v_fma_f32 v58, v58, s61, -v8
    v_fma_f32 v59, v59, s61, -v8
    v_fma_f32 v60, v60, s61, -v8
    v_fma_f32 v61, v61, s61, -v8
    v_fma_f32 v62, v62, s61, -v8
    v_fma_f32 v63, v63, s61, -v8
    v_fma_f32 v64, v64, s61, -v8
    v_fma_f32 v65, v65, s61, -v8
    v_fma_f32 v66, v66, s61, -v8
    v_fma_f32 v67, v67, s61, -v8
    v_fma_f32 v68, v68, s61, -v8
    v_fma_f32 v69, v69, s61, -v8
    v_fma_f32 v70, v70, s61, -v8
    v_fma_f32 v71, v71, s61, -v8
    v_fma_f32 v72, v72, s61, -v8
    v_fma_f32 v73, v73, s61, -v8
    v_fma_f32 v74, v74, s61, -v8
    v_fma_f32 v75, v75, s61, -v8
    v_fma_f32 v76, v76, s61, -v8
    v_fma_f32 v77, v77, s61, -v8
    v_fma_f32 v78, v78, s61, -v8
    v_fma_f32 v79, v79, s61, -v8
    v_fma_f32 v80, v80, s61, -v8
    v_fma_f32 v81, v81, s61, -v8
    v_fma_f32 v82, v82, s61, -v8
    v_fma_f32 v83, v83, s61, -v8
    v_fma_f32 v84, v84, s61, -v8
    v_fma_f32 v85, v85, s61, -v8
    v_fma_f32 v86, v86, s61, -v8
    v_fma_f32 v87, v87, s61, -v8
    v_fma_f32 v88, v88, s61, -v8
    v_fma_f32 v89, v89, s61, -v8
    v_fma_f32 v90, v90, s61, -v8
    v_fma_f32 v91, v91, s61, -v8
    v_fma_f32 v92, v92, s61, -v8
    v_fma_f32 v93, v93, s61, -v8
    v_fma_f32 v94, v94, s61, -v8
    v_fma_f32 v95, v95, s61, -v8
    v_exp_f32 v32, v32
    v_exp_f32 v33, v33
    v_exp_f32 v34, v34
    v_exp_f32 v35, v35
    v_exp_f32 v36, v36
    v_exp_f32 v37, v37
    v_exp_f32 v38, v38
    v_exp_f32 v39, v39
    v_exp_f32 v40, v40
    v_exp_f32 v41, v41
    v_exp_f32 v42, v42
    v_exp_f32 v43, v43
    v_exp_f32 v44, v44
    v_exp_f32 v45, v45
    v_exp_f32 v46, v46
    v_exp_f32 v47, v47
    v_exp_f32 v48, v48
    v_exp_f32 v49, v49
    v_exp_f32 v50, v50
    v_exp_f32 v51, v51
    v_exp_f32 v52, v52
    v_exp_f32 v53, v53
    v_exp_f32 v54, v54
    v_exp_f32 v55, v55
    v_exp_f32 v56, v56
    v_exp_f32 v57, v57
    v_exp_f32 v58, v58
    v_exp_f32 v59, v59
    v_exp_f32 v60, v60
    v_exp_f32 v61, v61
    v_exp_f32 v62, v62
    v_exp_f32 v63, v63
    v_exp_f32 v64, v64
    v_exp_f32 v65, v65
    v_exp_f32 v66, v66
    v_exp_f32 v67, v67
    v_exp_f32 v68, v68
    v_exp_f32 v69, v69
    v_exp_f32 v70, v70
    v_exp_f32 v71, v71
    v_exp_f32 v72, v72
    v_exp_f32 v73, v73
    v_exp_f32 v74, v74
    v_exp_f32 v75, v75
    v_exp_f32 v76, v76
    v_exp_f32 v77, v77
    v_exp_f32 v78, v78
    v_exp_f32 v79, v79
    v_exp_f32 v80, v80
    v_exp_f32 v81, v81
    v_exp_f32 v82, v82
    v_exp_f32 v83, v83
    v_exp_f32 v84, v84
    v_exp_f32 v85, v85
    v_exp_f32 v86, v86
    v_exp_f32 v87, v87
    v_exp_f32 v88, v88
    v_exp_f32 v89, v89
    v_exp_f32 v90, v90
    v_exp_f32 v91, v91
    v_exp_f32 v92, v92
    v_exp_f32 v93, v93
    v_exp_f32 v94, v94
    v_exp_f32 v95, v95
    v_add_f32 v9, v9, v32
    v_add_f32 v9, v9, v33
    v_add_f32 v9, v9, v34
    v_add_f32 v9, v9, v35
    v_add_f32 v9, v9, v36
    v_add_f32 v9, v9, v37
    v_add_f32 v9, v9, v38
    v_add_f32 v9, v9, v39
    v_add_f32 v9, v9, v40
    v_add_f32 v9, v9, v41
    v_add_f32 v9, v9, v42
    v_add_f32 v9, v9, v43
    v_add_f32 v9, v9, v44
    v_add_f32 v9, v9, v45
    v_add_f32 v9, v9, v46
    v_add_f32 v9, v9, v47
    v_add_f32 v9, v9, v48
    v_add_f32 v9, v9, v49
    v_add_f32 v9, v9, v50
    v_add_f32 v9, v9, v51
    v_add_f32 v9, v9, v52
    v_add_f32 v9, v9, v53
    v_add_f32 v9, v9, v54
    v_add_f32 v9, v9, v55
    v_add_f32 v9, v9, v56
    v_add_f32 v9, v9, v57
    v_add_f32 v9, v9, v58
    v_add_f32 v9, v9, v59
    v_add_f32 v9, v9, v60
    v_add_f32 v9, v9, v61
    v_add_f32 v9, v9, v62
    v_add_f32 v9, v9, v63
    v_add_f32 v9, v9, v64
    v_add_f32 v9, v9, v65
    v_add_f32 v9, v9, v66
    v_add_f32 v9, v9, v67
    v_add_f32 v9, v9, v68
    v_add_f32 v9, v9, v69
    v_add_f32 v9, v9, v70
    v_add_f32 v9, v9, v71
    v_add_f32 v9, v9, v72
    v_add_f32 v9, v9, v73
    v_add_f32 v9, v9, v74
    v_add_f32 v9, v9, v75
    v_add_f32 v9, v9, v76
    v_add_f32 v9, v9, v77
    v_add_f32 v9, v9, v78
    v_add_f32 v9, v9, v79
    v_add_f32 v9, v9, v80
    v_add_f32 v9, v9, v81
    v_add_f32 v9, v9, v82
    v_add_f32 v9, v9, v83
    v_add_f32 v9, v9, v84
    v_add_f32 v9, v9, v85
    v_add_f32 v9, v9, v86
    v_add_f32 v9, v9, v87
    v_add_f32 v9, v9, v88
    v_add_f32 v9, v9, v89
    v_add_f32 v9, v9, v90
    v_add_f32 v9, v9, v91
    v_add_f32 v9, v9, v92
    v_add_f32 v9, v9, v93
    v_add_f32 v9, v9, v94
    v_add_f32 v9, v9, v95
    s_nop 1
    v_add_f32_dpp v9, v9, v9 quad_perm:[1,0,3,2] row_mask:0xf bank_mask:0xf
    s_nop 1
    v_add_f32_dpp v9, v9, v9 quad_perm:[2,3,0,1] row_mask:0xf bank_mask:0xf
    s_nop 1
    v_add_f32_dpp v9, v9, v9 row_ror:4 row_mask:0xf bank_mask:0xf
    s_nop 1
    v_add_f32_dpp v9, v9, v9 row_ror:8 row_mask:0xf bank_mask:0xf
    s_nop 1
    v_add_f32_dpp v9, v9, v9 row_bcast:15 row_mask:0xa bank_mask:0xf
    s_nop 1
    v_add_f32_dpp v9, v9, v9 row_bcast:31 row_mask:0xc bank_mask:0xf
    s_nop 0
    v_readlane_b32 s58, v9, 63
    s_nop 1
    v_rcp_f32 v9, s58
    v_log_f32 v10, s58
    v_sub_f32 v4, v4, v8
    v_sub_f32 v5, v5, v8
    v_sub_f32 v6, v6, v8
    v_sub_f32 v7, v7, v8
    v_exp_f32 v4, v4
    v_exp_f32 v5, v5
    v_exp_f32 v6, v6
    v_exp_f32 v7, v7
    v_add_f32 v10, v10, v8
    v_mul_f32 v4, v4, v9
    v_mul_f32 v5, v5, v9
    v_mul_f32 v6, v6, v9
    v_mul_f32 v7, v7, v9
    v_mov_b32 v21, 156720
    ds_write_b128 v21, v[4:7]
    v_mov_b32 v11, 1
    ds_write_b64 v21, v[10:11] offset:16
    s_branch L_join
L_wipe:
    s_lshl_b32 s58, s66, 11
    v_lshl_add_u32 v21, v0, 5, s58
    v_mov_b32 v23, s67
    buffer_load_dwordx2 v[68:69], v21, s[44:47], 0 offen sc1 nt
    buffer_load_dwordx2 v[70:71], v21, s[44:47], 0 offen offset:16 sc1 nt
    s_mov_b32 s59, 0x0c0c0400
    v_not_b32 v72, v23
    v_mov_b32 v73, 0
    s_waitcnt vmcnt(0)
    v_perm_b32 v68, v69, v68, s59
    v_cmp_eq_u32 vcc, v23, v68
    s_cbranch_vccz L_wy0
    s_mov_b64 exec, vcc
    buffer_store_dwordx2 v[72:73], v21, s[44:47], 0 offen offset:0 sc1
    s_mov_b64 exec, -1
    s_waitcnt vmcnt(0)
L_wy0:
    v_perm_b32 v70, v71, v70, s59
    v_cmp_eq_u32 vcc, v23, v70
    s_cbranch_vccz L_wy1
    s_mov_b64 exec, vcc
    buffer_store_dwordx2 v[72:73], v21, s[44:47], 0 offen offset:16 sc1
    s_mov_b64 exec, -1
    s_waitcnt vmcnt(0)
L_wy1:
    s_mul_i32 s56, s67, 0x10001
    v_mov_b32 v68, s56
    v_mov_b32 v69, s56
    v_mov_b32 v70, s56
    v_mov_b32 v71, s56
    s_lshl_b32 s58, s66, 7
    s_add_u32 s58, s58, 0x1a0000
    v_lshl_add_u32 v72, v0, 4, s58
    s_and_b32 s58, s66, 0xf1
    s_andn2_b32 s58, s58, 1
    s_lshl_b32 s58, s58, 7
    s_add_u32 s58, s58, 0x1a0000
    v_lshl_add_u32 v73, v0, 8, s58
    s_add_u32 s30, s28, s58
    s_addc_u32 s31, s29, 0
    v_mov_b32 v74, 156752
    s_mul_i32 s89, s76, 0x10001
    v_mov_b32 v76, s89
    v_mov_b32 v77, s89
    v_mov_b32 v78, s89
    v_mov_b32 v79, s89
    s_and_b32 s58, s2, 7
    s_lshl_b32 s58, s58, 12
    s_add_u32 s58, s58, 0x1a0000
    v_lshl_add_u32 v81, v0, 7, s58
    s_lshr_b32 s59, s2, 3
    s_lshl_b32 s59, s59, 7
    s_add_u32 s58, s58, s59
    v_lshl_add_u32 v80, v0, 4, s58
    s_mov_b32 s90, 64
    s_mov_b32 s91, 12
    s_mov_b32 s59, 1376256
    v_mov_b32 v21, 158816
    s_mov_b32 s57, 262144
L_kp0_w:
    ds_read_b32 v22, v21
    s_waitcnt lgkmcnt(0)
    v_readfirstlane_b32 s58, v22
    s_nop 1
    s_cmp_ge_u32 s58, s59
    s_cbranch_scc1 L_kp0_go
    s_sleep 4
    s_sub_u32 s57, s57, 1
    s_cmp_lg_u32 s57, 0
    s_cbranch_scc1 L_kp0_w
L_kp0_go:
    s_mov_b32 s60, 294912
    s_mov_b32 exec_hi, 0
    buffer_load_dword v75, v81, s[44:47], s60 offen sc1
    s_mov_b64 exec, 0xff
    buffer_store_dwordx4 v[76:79], v80, s[44:47], s60 offen
    s_mov_b32 exec_lo, -1
    s_waitcnt vmcnt(1)
    v_cmp_eq_u32 vcc, s89, v75
    s_mov_b64 exec, -1
    s_bcnt1_i32_b64 s58, vcc
    s_sub_i32 s58, s58, 12
    s_max_i32 s58, s58, 0
    s_mul_i32 s58, s58, 1
    s_lshr_b32 s58, s58, 1
    s_min_u32 s58, s58, 10
    s_sub_i32 s58, 10, s58
    v_mov_b32 v22, s58
    ds_write_b32 v74, v22 offset:8
    s_mov_b32 s59, 2097152
    v_mov_b32 v21, 158816
    s_mov_b32 s57, 262144
L_cp0_w:
    ds_read_b32 v22, v21
    s_waitcnt lgkmcnt(0)
    v_readfirstlane_b32 s58, v22
    s_nop 1
    s_cmp_ge_u32 s58, s59
    s_cbranch_scc1 L_cp0_go
    s_sleep 4
    s_sub_u32 s57, s57, 1
    s_cmp_lg_u32 s57, 0
    s_cbranch_scc1 L_cp0_w
L_cp0_go:
    s_mov_b32 s60, 0
    s_mov_b32 exec_hi, 0
    buffer_load_dword v75, v81, s[44:47], s60 offen sc1
    s_mov_b64 exec, 0xff
    buffer_store_dwordx4 v[76:79], v80, s[44:47], s60 offen
    s_mov_b32 exec_lo, -1
    s_waitcnt vmcnt(1)
    v_cmp_eq_u32 vcc, s89, v75
    s_mov_b64 exec, -1
    s_bcnt1_i32_b64 s58, vcc
    s_sub_i32 s58, s58, s91
    s_max_i32 s58, s58, 0
    s_lshr_b32 s58, s58, 2
    s_min_u32 s58, s58, 4
    s_sub_i32 s58, 13, s58
    s_min_i32 s58, s58, s90
    v_mov_b32 v22, s58
    ds_write_b32 v74, v22
    s_mov_b32 s59, 2621440
    v_mov_b32 v21, 158816
    s_mov_b32 s57, 262144
L_cp1_w:
    ds_read_b32 v22, v21
    s_waitcnt lgkmcnt(0)
    v_readfirstlane_b32 s58, v22
    s_nop 1
    s_cmp_ge_u32 s58, s59
    s_cbranch_scc1 L_cp1_go
    s_sleep 4
    s_sub_u32 s57, s57, 1
    s_cmp_lg_u32 s57, 0
    s_cbranch_scc1 L_cp1_w
L_cp1_go:
    s_mov_b32 s60, 32768
    s_mov_b32 exec_hi, 0
    buffer_load_dword v75, v81, s[44:47], s60 offen sc1
    s_mov_b64 exec, 0xff
    buffer_store_dwordx4 v[76:79], v80, s[44:47], s60 offen
    s_mov_b32 exec_lo, -1
    s_waitcnt vmcnt(1)
    v_cmp_eq_u32 vcc, s89, v75
    s_mov_b64 exec, -1
    s_bcnt1_i32_b64 s58, vcc
    s_sub_i32 s58, s58, s91
    s_max_i32 s58, s58, 0
    s_lshr_b32 s58, s58, 2
    s_min_u32 s58, s58, 4
    s_sub_i32 s58, 9, s58
    s_min_i32 s58, s58, s90
    v_mov_b32 v22, s58
    ds_write_b32 v74, v22
    s_mov_b32 s59, 3145728
    v_mov_b32 v21, 158816
    s_mov_b32 s57, 262144
L_cp2_w:
    ds_read_b32 v22, v21
    s_waitcnt lgkmcnt(0)
    v_readfirstlane_b32 s58, v22
    s_nop 1
    s_cmp_ge_u32 s58, s59
    s_cbranch_scc1 L_cp2_go
    s_sleep 4
    s_sub_u32 s57, s57, 1
    s_cmp_lg_u32 s57, 0
    s_cbranch_scc1 L_cp2_w
L_cp2_go:
    s_mov_b32 s60, 65536
    s_mov_b32 exec_hi, 0
    buffer_load_dword v75, v81, s[44:47], s60 offen sc1
    s_mov_b64 exec, 0xff
    buffer_store_dwordx4 v[76:79], v80, s[44:47], s60 offen
    s_mov_b32 exec_lo, -1
    s_waitcnt vmcnt(1)
    v_cmp_eq_u32 vcc, s89, v75
    s_mov_b64 exec, -1
    s_bcnt1_i32_b64 s58, vcc
    s_sub_i32 s58, s58, s91
    s_max_i32 s58, s58, 0
    s_lshr_b32 s58, s58, 2
    s_min_u32 s58, s58, 4
    s_sub_i32 s58, 5, s58
    s_min_i32 s58, s58, s90
    v_mov_b32 v22, s58
    ds_write_b32 v74, v22
    s_branch L_join
L_gate:
    s_and_b32 s88, s2, 7
    s_lshl_b32 s88, s88, 3
    s_lshr_b32 s89, s2, 6
    s_lshl_b32 s89, s89, 1
    s_add_u32 s88, s88, s89
    s_add_u32 s88, s88, s54
    s_lshl_b32 s89, s53, 6
    s_add_u32 s88, s88, s89
    s_mov_b32 s36, s22
    s_mov_b32 s37, s23
    s_mov_b32 s38, 1024
    s_mov_b32 s39, 0x20000
    v_lshlrev_b32 v21, 4, v0
    s_lshl_b32 s58, s53, 10
    buffer_load_dwordx4 v[68:71], v21, s[48:51], s58 offen
    buffer_load_dwordx4 v[72:75], v21, s[36:39], 0 offen
    s_waitcnt vmcnt(0)
    v_mov_b32 v84, 0
    v_lshlrev_b32 v21, 16, v68
    v_lshlrev_b32 v22, 16, v72
    v_mul_f32 v21, v21, v22
    v_cvt_pk_bf16_f32 v21, 0, v21
    v_add_f32 v84, v84, v21
    v_and_b32 v21, 0xffff0000, v68
    v_and_b32 v22, 0xffff0000, v72
    v_mul_f32 v21, v21, v22
    v_cvt_pk_bf16_f32 v21, 0, v21
    v_add_f32 v84, v84, v21
    v_lshlrev_b32 v21, 16, v69
    v_lshlrev_b32 v22, 16, v73
    v_mul_f32 v21, v21, v22
    v_cvt_pk_bf16_f32 v21, 0, v21
    v_add_f32 v84, v84, v21
    v_and_b32 v21, 0xffff0000, v69
    v_and_b32 v22, 0xffff0000, v73
    v_mul_f32 v21, v21, v22
    v_cvt_pk_bf16_f32 v21, 0, v21
    v_add_f32 v84, v84, v21
    v_lshlrev_b32 v21, 16, v70
    v_lshlrev_b32 v22, 16, v74
    v_mul_f32 v21, v21, v22
    v_cvt_pk_bf16_f32 v21, 0, v21
    v_add_f32 v84, v84, v21
    v_and_b32 v21, 0xffff0000, v70
    v_and_b32 v22, 0xffff0000, v74
    v_mul_f32 v21, v21, v22
    v_cvt_pk_bf16_f32 v21, 0, v21
    v_add_f32 v84, v84, v21
    v_lshlrev_b32 v21, 16, v71
    v_lshlrev_b32 v22, 16, v75
    v_mul_f32 v21, v21, v22
    v_cvt_pk_bf16_f32 v21, 0, v21
    v_add_f32 v84, v84, v21
    v_and_b32 v21, 0xffff0000, v71
    v_and_b32 v22, 0xffff0000, v75
    v_mul_f32 v21, v21, v22
    v_cvt_pk_bf16_f32 v21, 0, v21
    v_add_f32 v84, v84, v21
    s_nop 1
    v_add_f32_dpp v84, v84, v84 quad_perm:[1,0,3,2] row_mask:0xf bank_mask:0xf
    s_nop 1
    v_add_f32_dpp v84, v84, v84 quad_perm:[2,3,0,1] row_mask:0xf bank_mask:0xf
    s_nop 1
    v_add_f32_dpp v84, v84, v84 row_ror:4 row_mask:0xf bank_mask:0xf
    s_nop 1
    v_add_f32_dpp v84, v84, v84 row_ror:8 row_mask:0xf bank_mask:0xf
    s_nop 1
    v_add_f32_dpp v84, v84, v84 row_bcast:15 row_mask:0xa bank_mask:0xf
    s_nop 1
    v_add_f32_dpp v84, v84, v84 row_bcast:31 row_mask:0xc bank_mask:0xf
    s_nop 0
    v_readlane_b32 s58, v84, 63
    s_nop 1
    v_mov_b32 v84, s58
    v_cvt_pk_bf16_f32 v84, 0, v84
    v_mul_f32 v84, 0xbfb8aa3b, v84
    v_exp_f32 v84, v84
    s_nop 0
    v_add_f32 v84, 1.0, v84
    v_rcp_f32 v84, v84
    s_nop 0
    v_cvt_pk_bf16_f32 v84, 0, v84
    v_bfe_u32 v21, v0, 5, 1
    v_bfe_u32 v22, v0, 4, 1
    v_bfe_u32 v23, v0, 3, 1
    v_lshl_add_u32 v21, v22, 1, v21
    v_lshl_add_u32 v21, v23, 2, v21
    s_lshl_b32 s58, s88, 4
    v_lshl_add_u32 v87, v21, 1, s58
    s_lshr_b32 s59, s2, 3
    s_add_u32 s59, s59, 84
    s_lshl_b32 s59, s59, 15
    v_mov_b32 v21, 158816
    s_mov_b32 s57, 262144
L_ck_w:
    ds_read_b32 v22, v21
    s_waitcnt lgkmcnt(0)
    v_readfirstlane_b32 s58, v22
    s_nop 1
    s_cmp_ge_u32 s58, s59
    s_cbranch_scc1 L_ck_go
    s_sleep 32
    s_sub_u32 s57, s57, 1
    s_cmp_lg_u32 s57, 0
    s_cbranch_scc1 L_ck_w
L_ck_go:
    s_bfe_u32 s58, s88, 0x20004
    s_lshl_b32 s58, s58, 11
    s_lshl_b32 s59, s53, 8
    s_add_u32 s58, s58, s59
    s_and_b32 s59, s88, 15
    s_lshl_b32 s59, s59, 4
    s_add_u32 s58, s58, s59
    s_add_u32 s58, s58, 0x100000
    v_lshl_add_u32 v21, v0, 13, s58
    v_mov_b32 v68, 0
    v_mov_b32 v69, 0
    v_mov_b32 v70, 0
    v_mov_b32 v71, 0
    v_mov_b32 v72, 0
    v_mov_b32 v73, 0
    v_mov_b32 v74, 0
    v_mov_b32 v75, 0
    s_mov_b32 s59, 0x0c0c0400
    s_mul_i32 s56, s67, 0x10001
    s_mov_b32 s57, 262144
    s_mov_b64 exec, 0x7ff
L_c2:
    buffer_load_dwordx4 v[68:71], v21, s[44:47], 0 offen sc1
    buffer_load_dwordx4 v[72:75], v21, s[44:47], 0 offen offset:1024 sc1
    s_waitcnt vmcnt(0)
    v_perm_b32 v22, v69, v68, s59
    v_perm_b32 v23, v73, v72, s59
    v_perm_b32 v22, v23, v22, s63
    v_cmp_ne_u32 vcc, s56, v22
    s_cbranch_vccz L_c2_ok
    s_mov_b64 exec, vcc
    s_sleep 64
    s_sub_u32 s57, s57, 1
    s_cmp_lg_u32 s57, 0
    s_cbranch_scc1 L_c2
L_c2_ok:
    s_mov_b64 exec, -1
    v_and_b32 v68, 0xffffff00, v68
    v_and_b32 v69, 0xffffff00, v69
    v_and_b32 v72, 0xffffff00, v72
    v_and_b32 v73, 0xffffff00, v73
    s_nop 1
    v_permlane32_swap_b32 v68, v69
    v_permlane32_swap_b32 v70, v71
    v_permlane32_swap_b32 v72, v73
    v_permlane32_swap_b32 v74, v75
    v_add_f32 v68, v68, v69
    v_add_f32 v70, v70, v71
    v_add_f32 v72, v72, v73
    v_add_f32 v74, v74, v75
    s_nop 0
    v_permlane16_swap_b32 v68, v70
    v_permlane16_swap_b32 v72, v74
    v_add_f32 v68, v68, v70
    v_add_f32 v72, v72, v74
    s_nop 0
    v_add_f32_dpp v69, v68, v68 row_ror:8 row_mask:0xf bank_mask:0x3
    v_add_f32_dpp v69, v72, v72 row_ror:8 row_mask:0xf bank_mask:0xc
    s_nop 1
    v_add_f32_dpp v69, v69, v69 row_half_mirror row_mask:0xf bank_mask:0xf
    s_nop 1
    v_add_f32_dpp v69, v69, v69 quad_perm:[1,0,3,2] row_mask:0xf bank_mask:0xf
    s_nop 1
    v_add_f32_dpp v68, v69, v69 quad_perm:[2,3,0,1] row_mask:0xf bank_mask:0xf
    v_sub_f32 v21, 1.0, v84
    v_cvt_pk_bf16_f32 v68, 0, v68
    v_cvt_pk_bf16_f32 v21, 0, v21
    v_mul_f32 v85, v68, v21
    v_cvt_pk_bf16_f32 v85, 0, v85
    v_lshlrev_b32 v22, 4, v0
    v_add_u32 v22, 157792, v22
    ds_write_b128 v22, v[84:87]
    s_branch L_join
L_ffn:
    s_cmp_lt_u32 s2, 88
    s_cbranch_scc1 L_fgo
    s_cmp_lt_u32 s2, 128
    s_cbranch_scc1 L_join
    s_cmp_ge_u32 s2, 172
    s_cbranch_scc1 L_join
L_fgo:
    v_mov_b32 v25, s76
    v_cmp_eq_u32 vcc, 1, v28
    v_mov_b32 v21, s77
    s_nop 0
    v_cndmask_b32 v25, v25, v21, vcc
    v_cmp_eq_u32 vcc, 2, v28
    v_mov_b32 v21, s78
    s_nop 0
    v_cndmask_b32 v25, v25, v21, vcc
    v_cmp_eq_u32 vcc, 3, v28
    v_mov_b32 v21, s79
    s_nop 0
    v_cndmask_b32 v25, v25, v21, vcc
    v_lshlrev_b32 v19, 4, v0
    v_add_u32 v19, 4096, v19
    v_lshrrev_b32 v21, 2, v29
    v_lshlrev_b32 v21, 8, v21
    v_lshl_add_u32 v20, v28, 4, v21
    v_add_u32 v20, 4096, v20
    s_and_b32 s69, s2, 3
    s_cmp_ge_u32 s2, 128
    s_cbranch_scc1 L_fdown
    s_lshr_b32 s68, s2, 3
    v_lshlrev_b32 v21, 10, v28
    v_lshl_add_u32 v21, v29, 4, v21
    s_lshl_b32 s58, s69, 8
    buffer_load_dwordx4 v[2:5], v21, s[48:51], s58 offen
    s_lshl_b32 s58, s2, 11
    s_add_u32 s58, s58, 0x120000
    v_lshl_add_u32 v24, v0, 4, s58
    buffer_load_dwordx2 v[68:69], v24, s[44:47], 0 offen sc1 nt
    buffer_load_dwordx2 v[70:71], v24, s[44:47], 0 offen offset:1024 sc1 nt
    s_mov_b32 s59, 0x0c0c0400
    v_not_b32 v72, v25
    v_mov_b32 v73, 0
    s_waitcnt vmcnt(0)
    v_perm_b32 v68, v69, v68, s59
    v_cmp_eq_u32 vcc, v25, v68
    s_cbranch_vccz L_w10
    s_mov_b64 exec, vcc
    buffer_store_dwordx2 v[72:73], v24, s[44:47], 0 offen offset:0 sc1
    s_mov_b64 exec, -1
    s_waitcnt vmcnt(0)
L_w10:
    v_perm_b32 v70, v71, v70, s59
    v_cmp_eq_u32 vcc, v25, v70
    s_cbranch_vccz L_w11
    s_mov_b64 exec, vcc
    buffer_store_dwordx2 v[72:73], v24, s[44:47], 0 offen offset:1024 sc1
    s_mov_b64 exec, -1
    s_waitcnt vmcnt(0)
L_w11:
    s_waitcnt vmcnt(0)
    ds_write_b128 v19, v[2:5]
    s_bitcmp1_b32 s2, 2
    s_cselect_b32 s32, s18, s16
    s_cselect_b32 s33, s19, s17
    s_mov_b32 s34, 1409024
    s_mov_b32 s35, 0x20000
    s_cmp_eq_u32 s68, 10
    s_cselect_b32 s58, 11, 15
    v_min_u32 v21, s58, v29
    s_mul_i32 s58, s69, 352256
    s_lshl_b32 s59, s68, 8
    s_add_u32 s58, s58, s59
    v_lshl_add_u32 v21, v21, 4, s58
    v_mul_u32_u24 v22, 22016, v28
    v_add_u32 v18, v21, v22
    v_mov_b32 v32, 0
    v_mov_b32 v33, 0
    v_mov_b32 v34, 0
    v_mov_b32 v35, 0
    v_mov_b32 v36, 0
    v_mov_b32 v37, 0
    v_mov_b32 v38, 0
    v_mov_b32 v39, 0
    v_mov_b32 v40, 0
    v_mov_b32 v41, 0
    v_mov_b32 v42, 0
    v_mov_b32 v43, 0
    v_mov_b32 v44, 0
    v_mov_b32 v45, 0
    v_mov_b32 v46, 0
    v_mov_b32 v47, 0
    v_mov_b32 v48, 0
    v_mov_b32 v49, 0
    v_mov_b32 v50, 0
    v_mov_b32 v51, 0
    v_mov_b32 v52, 0
    v_mov_b32 v53, 0
    v_mov_b32 v54, 0
    v_mov_b32 v55, 0
    v_mov_b32 v56, 0
    v_mov_b32 v57, 0
    v_mov_b32 v58, 0
    v_mov_b32 v59, 0
    v_mov_b32 v60, 0
    v_mov_b32 v61, 0
    v_mov_b32 v62, 0
    v_mov_b32 v63, 0
    s_mov_b32 s57, 4
L_f1:
    s_waitcnt lgkmcnt(0)
    ds_read_b128 v[2:5], v20
    s_mov_b32 s56, 0
    buffer_load_dwordx4 v[224:227], v18, s[32:35], s56 offen nt
    s_mov_b32 s56, 2752
    buffer_load_dwordx4 v[228:231], v18, s[32:35], s56 offen nt
    s_mov_b32 s56, 5504
    buffer_load_dwordx4 v[232:235], v18, s[32:35], s56 offen nt
    s_mov_b32 s56, 8256
    buffer_load_dwordx4 v[236:239], v18, s[32:35], s56 offen nt
    s_mov_b32 s56, 11008
    buffer_load_dwordx4 v[240:243], v18, s[32:35], s56 offen nt
    s_mov_b32 s56, 13760
    buffer_load_dwordx4 v[244:247], v18, s[32:35], s56 offen nt
    s_mov_b32 s56, 16512
    buffer_load_dwordx4 v[248:251], v18, s[32:35], s56 offen nt
    s_mov_b32 s56, 19264
    buffer_load_dwordx4 v[252:255], v18, s[32:35], s56 offen nt
    v_add_u32 v18, 88064, v18
    v_add_u32 v20, 64, v20
    s_waitcnt vmcnt(0) lgkmcnt(0)
    v_perm_b32 v64, v228, v224, s63
    v_perm_b32 v65, v236, v232, s63
    v_perm_b32 v66, v244, v240, s63
    v_perm_b32 v67, v252, v248, s63
    v_perm_b32 v68, v228, v224, s64
    v_perm_b32 v69, v236, v232, s64
    v_perm_b32 v70, v244, v240, s64
    v_perm_b32 v71, v252, v248, s64
    v_perm_b32 v72, v229, v225, s63
    v_perm_b32 v73, v237, v233, s63
    v_perm_b32 v74, v245, v241, s63
    v_perm_b32 v75, v253, v249, s63
    v_perm_b32 v76, v229, v225, s64
    v_perm_b32 v77, v237, v233, s64
    v_perm_b32 v78, v245, v241, s64
    v_perm_b32 v79, v253, v249, s64
    v_perm_b32 v80, v230, v226, s63
    v_perm_b32 v81, v238, v234, s63
    v_perm_b32 v82, v246, v242, s63
    v_perm_b32 v83, v254, v250, s63
    v_perm_b32 v84, v230, v226, s64
    v_perm_b32 v85, v238, v234, s64
    v_perm_b32 v86, v246, v242, s64
    v_perm_b32 v87, v254, v250, s64
    v_perm_b32 v88, v231, v227, s63
    v_perm_b32 v89, v239, v235, s63
    v_perm_b32 v90, v247, v243, s63
    v_perm_b32 v91, v255, v251, s63
    v_perm_b32 v92, v231, v227, s64
    v_perm_b32 v93, v239, v235, s64
    v_perm_b32 v94, v247, v243, s64
    v_perm_b32 v95, v255, v251, s64
    s_nop 1
    v_mfma_f32_16x16x32_bf16 v[32:35], v[2:5], v[64:67], v[32:35]
    v_mfma_f32_16x16x32_bf16 v[36:39], v[2:5], v[68:71], v[36:39]
    v_mfma_f32_16x16x32_bf16 v[40:43], v[2:5], v[72:75], v[40:43]
    v_mfma_f32_16x16x32_bf16 v[44:47], v[2:5], v[76:79], v[44:47]
    v_mfma_f32_16x16x32_bf16 v[48:51], v[2:5], v[80:83], v[48:51]
    v_mfma_f32_16x16x32_bf16 v[52:55], v[2:5], v[84:87], v[52:55]
    v_mfma_f32_16x16x32_bf16 v[56:59], v[2:5], v[88:91], v[56:59]
    v_mfma_f32_16x16x32_bf16 v[60:63], v[2:5], v[92:95], v[60:63]
    s_sub_u32 s57, s57, 1
    s_cmp_lg_u32 s57, 0
    s_cbranch_scc1 L_f1
    s_branch L_fout
L_fdown:
    s_sub_u32 s68, s2, 128
    s_lshr_b32 s68, s68, 2
    s_lshl_b32 s58, s68, 13
    s_lshl_b32 s59, s69, 11
    s_add_u32 s58, s58, s59
    s_add_u32 s58, s58, 0x100000
    v_lshl_add_u32 v24, v0, 4, s58
    buffer_load_dwordx2 v[68:69], v24, s[44:47], 0 offen sc1 nt
    buffer_load_dwordx2 v[70:71], v24, s[44:47], 0 offen offset:1024 sc1 nt
    s_mov_b32 s59, 0x0c0c0400
    v_not_b32 v72, v25
    v_mov_b32 v73, 0
    s_waitcnt vmcnt(0)
    v_perm_b32 v68, v69, v68, s59
    v_cmp_eq_u32 vcc, v25, v68
    s_cbranch_vccz L_w20
    s_mov_b64 exec, vcc
    buffer_store_dwordx2 v[72:73], v24, s[44:47], 0 offen offset:0 sc1
    s_mov_b64 exec, -1
    s_waitcnt vmcnt(0)
L_w20:
    v_perm_b32 v70, v71, v70, s59
    v_cmp_eq_u32 vcc, v25, v70
    s_cbranch_vccz L_w21
    s_mov_b64 exec, vcc
    buffer_store_dwordx2 v[72:73], v24, s[44:47], 0 offen offset:1024 sc1
    s_mov_b64 exec, -1
    s_waitcnt vmcnt(0)
L_w21:
    s_mov_b32 s59, 1966080
    v_mov_b32 v21, 158816
    s_mov_b32 s57, 262144
L_f2w_w:
    ds_read_b32 v22, v21
    s_waitcnt lgkmcnt(0)
    v_readfirstlane_b32 s58, v22
    s_nop 1
    s_cmp_ge_u32 s58, s59
    s_cbranch_scc1 L_f2w_go
    s_sleep 32
    s_sub_u32 s57, s57, 1
    s_cmp_lg_u32 s57, 0
    s_cbranch_scc1 L_f2w_w
L_f2w_go:
    s_lshl_b32 s58, s68, 14
    s_add_u32 s58, s58, 0x120000
    v_lshl_add_u32 v18, v0, 4, s58
    v_mul_u32_u24 v26, 0x10001, v25
    s_mov_b32 s59, 0x0c0c0400
    s_mov_b32 s57, 262144
L_f2p:
    s_mov_b32 s56, 0
    buffer_load_dwordx4 v[32:35], v18, s[44:47], s56 offen sc1
    buffer_load_dwordx4 v[36:39], v18, s[44:47], s56 offen offset:1024 sc1
    s_mov_b32 s56, 2048
    buffer_load_dwordx4 v[40:43], v18, s[44:47], s56 offen sc1
    buffer_load_dwordx4 v[44:47], v18, s[44:47], s56 offen offset:1024 sc1
    s_mov_b32 s56, 4096
    buffer_load_dwordx4 v[48:51], v18, s[44:47], s56 offen sc1
    buffer_load_dwordx4 v[52:55], v18, s[44:47], s56 offen offset:1024 sc1
    s_mov_b32 s56, 6144
    buffer_load_dwordx4 v[56:59], v18, s[44:47], s56 offen sc1
    buffer_load_dwordx4 v[60:63], v18, s[44:47], s56 offen offset:1024 sc1
    s_mov_b32 s56, 8192
    buffer_load_dwordx4 v[64:67], v18, s[44:47], s56 offen sc1
    buffer_load_dwordx4 v[68:71], v18, s[44:47], s56 offen offset:1024 sc1
    s_mov_b32 s56, 10240
    buffer_load_dwordx4 v[72:75], v18, s[44:47], s56 offen sc1
    buffer_load_dwordx4 v[76:79], v18, s[44:47], s56 offen offset:1024 sc1
    s_mov_b32 s56, 12288
    buffer_load_dwordx4 v[80:83], v18, s[44:47], s56 offen sc1
    buffer_load_dwordx4 v[84:87], v18, s[44:47], s56 offen offset:1024 sc1
    s_mov_b32 s56, 14336
    buffer_load_dwordx4 v[88:91], v18, s[44:47], s56 offen sc1
    buffer_load_dwordx4 v[92:95], v18, s[44:47], s56 offen offset:1024 sc1
    v_mov_b32 v27, 0
    s_waitcnt vmcnt(0)
    v_perm_b32 v22, v33, v32, s59
    v_perm_b32 v23, v37, v36, s59
    v_perm_b32 v22, v23, v22, s63
    v_xor_b32 v22, v22, v26
    v_or_b32 v27, v27, v22
    v_perm_b32 v22, v41, v40, s59
    v_perm_b32 v23, v45, v44, s59
    v_perm_b32 v22, v23, v22, s63
    v_xor_b32 v22, v22, v26
    v_or_b32 v27, v27, v22
    v_perm_b32 v22, v49, v48, s59
    v_perm_b32 v23, v53, v52, s59
    v_perm_b32 v22, v23, v22, s63
    v_xor_b32 v22, v22, v26
    v_or_b32 v27, v27, v22
    v_perm_b32 v22, v57, v56, s59
    v_perm_b32 v23, v61, v60, s59
    v_perm_b32 v22, v23, v22, s63
    v_xor_b32 v22, v22, v26
    v_or_b32 v27, v27, v22
    v_perm_b32 v22, v65, v64, s59
    v_perm_b32 v23, v69, v68, s59
    v_perm_b32 v22, v23, v22, s63
    v_xor_b32 v22, v22, v26
    v_or_b32 v27, v27, v22
    v_perm_b32 v22, v73, v72, s59
    v_perm_b32 v23, v77, v76, s59
    v_perm_b32 v22, v23, v22, s63
    v_xor_b32 v22, v22, v26
    v_or_b32 v27, v27, v22
    v_perm_b32 v22, v81, v80, s59
    v_perm_b32 v23, v85, v84, s59
    v_perm_b32 v22, v23, v22, s63
    v_xor_b32 v22, v22, v26
    v_or_b32 v27, v27, v22
    v_perm_b32 v22, v89, v88, s59
    v_perm_b32 v23, v93, v92, s59
    v_perm_b32 v22, v23, v22, s63
    v_xor_b32 v22, v22, v26
    v_or_b32 v27, v27, v22
    v_cmp_ne_u32 vcc, 0, v27
    s_cbranch_vccz L_f2ok
    s_sleep 64
    s_sub_u32 s57, s57, 1
    s_cmp_lg_u32 s57, 0
    s_cbranch_scc1 L_f2p
L_f2ok:
    v_and_b32 v32, 0xffffff00, v32
    v_and_b32 v33, 0xffffff00, v33
    v_and_b32 v36, 0xffffff00, v36
    v_and_b32 v37, 0xffffff00, v37
    v_and_b32 v40, 0xffffff00, v40
    v_and_b32 v41, 0xffffff00, v41
    v_and_b32 v44, 0xffffff00, v44
    v_and_b32 v45, 0xffffff00, v45
    v_and_b32 v48, 0xffffff00, v48
    v_and_b32 v49, 0xffffff00, v49
    v_and_b32 v52, 0xffffff00, v52
    v_and_b32 v53, 0xffffff00, v53
    v_and_b32 v56, 0xffffff00, v56
    v_and_b32 v57, 0xffffff00, v57
    v_and_b32 v60, 0xffffff00, v60
    v_and_b32 v61, 0xffffff00, v61
    v_and_b32 v64, 0xffffff00, v64
    v_and_b32 v65, 0xffffff00, v65
    v_and_b32 v68, 0xffffff00, v68
    v_and_b32 v69, 0xffffff00, v69
    v_and_b32 v72, 0xffffff00, v72
    v_and_b32 v73, 0xffffff00, v73
    v_and_b32 v76, 0xffffff00, v76
    v_and_b32 v77, 0xffffff00, v77
    v_and_b32 v80, 0xffffff00, v80
    v_and_b32 v81, 0xffffff00, v81
    v_and_b32 v84, 0xffffff00, v84
    v_and_b32 v85, 0xffffff00, v85
    v_and_b32 v88, 0xffffff00, v88
    v_and_b32 v89, 0xffffff00, v89
    v_and_b32 v92, 0xffffff00, v92
    v_and_b32 v93, 0xffffff00, v93
    v_add_f32 v32, v32, v40
    v_add_f32 v48, v48, v56
    v_add_f32 v32, v32, v48
    v_add_f32 v33, v33, v41
    v_add_f32 v49, v49, v57
    v_add_f32 v33, v33, v49
    v_add_f32 v34, v34, v42
    v_add_f32 v50, v50, v58
    v_add_f32 v34, v34, v50
    v_add_f32 v35, v35, v43
    v_add_f32 v51, v51, v59
    v_add_f32 v35, v35, v51
    v_add_f32 v36, v36, v44
    v_add_f32 v52, v52, v60
    v_add_f32 v36, v36, v52
    v_add_f32 v37, v37, v45
    v_add_f32 v53, v53, v61
    v_add_f32 v37, v37, v53
    v_add_f32 v38, v38, v46
    v_add_f32 v54, v54, v62
    v_add_f32 v38, v38, v54
    v_add_f32 v39, v39, v47
    v_add_f32 v55, v55, v63
    v_add_f32 v39, v39, v55
    v_add_f32 v64, v64, v72
    v_add_f32 v80, v80, v88
    v_add_f32 v64, v64, v80
    v_add_f32 v65, v65, v73
    v_add_f32 v81, v81, v89
    v_add_f32 v65, v65, v81
    v_add_f32 v66, v66, v74
    v_add_f32 v82, v82, v90
    v_add_f32 v66, v66, v82
    v_add_f32 v67, v67, v75
    v_add_f32 v83, v83, v91
    v_add_f32 v67, v67, v83
    v_add_f32 v68, v68, v76
    v_add_f32 v84, v84, v92
    v_add_f32 v68, v68, v84
    v_add_f32 v69, v69, v77
    v_add_f32 v85, v85, v93
    v_add_f32 v69, v69, v85
    v_add_f32 v70, v70, v78
    v_add_f32 v86, v86, v94
    v_add_f32 v70, v70, v86
    v_add_f32 v71, v71, v79
    v_add_f32 v87, v87, v95
    v_add_f32 v71, v71, v87
    v_cvt_pk_bf16_f32 v32, 0, v32
    v_cvt_pk_bf16_f32 v64, 0, v64
    v_mul_f32 v21, 0xbfb8aa3b, v32
    v_exp_f32 v21, v21
    s_nop 0
    v_add_f32 v21, 1.0, v21
    v_rcp_f32 v21, v21
    s_nop 0
    v_mul_f32 v32, v32, v21
    v_cvt_pk_bf16_f32 v32, 0, v32
    v_mul_f32 v32, v32, v64
    v_cvt_pk_bf16_f32 v33, 0, v33
    v_cvt_pk_bf16_f32 v65, 0, v65
    v_mul_f32 v21, 0xbfb8aa3b, v33
    v_exp_f32 v21, v21
    s_nop 0
    v_add_f32 v21, 1.0, v21
    v_rcp_f32 v21, v21
    s_nop 0
    v_mul_f32 v33, v33, v21
    v_cvt_pk_bf16_f32 v33, 0, v33
    v_mul_f32 v33, v33, v65
    v_cvt_pk_bf16_f32 v34, 0, v34
    v_cvt_pk_bf16_f32 v66, 0, v66
    v_mul_f32 v21, 0xbfb8aa3b, v34
    v_exp_f32 v21, v21
    s_nop 0
    v_add_f32 v21, 1.0, v21
    v_rcp_f32 v21, v21
    s_nop 0
    v_mul_f32 v34, v34, v21
    v_cvt_pk_bf16_f32 v34, 0, v34
    v_mul_f32 v34, v34, v66
    v_cvt_pk_bf16_f32 v35, 0, v35
    v_cvt_pk_bf16_f32 v67, 0, v67
    v_mul_f32 v21, 0xbfb8aa3b, v35
    v_exp_f32 v21, v21
    s_nop 0
    v_add_f32 v21, 1.0, v21
    v_rcp_f32 v21, v21
    s_nop 0
    v_mul_f32 v35, v35, v21
    v_cvt_pk_bf16_f32 v35, 0, v35
    v_mul_f32 v35, v35, v67
    v_cvt_pk_bf16_f32 v36, 0, v36
    v_cvt_pk_bf16_f32 v68, 0, v68
    v_mul_f32 v21, 0xbfb8aa3b, v36
    v_exp_f32 v21, v21
    s_nop 0
    v_add_f32 v21, 1.0, v21
    v_rcp_f32 v21, v21
    s_nop 0
    v_mul_f32 v36, v36, v21
    v_cvt_pk_bf16_f32 v36, 0, v36
    v_mul_f32 v36, v36, v68
    v_cvt_pk_bf16_f32 v37, 0, v37
    v_cvt_pk_bf16_f32 v69, 0, v69
    v_mul_f32 v21, 0xbfb8aa3b, v37
    v_exp_f32 v21, v21
    s_nop 0
    v_add_f32 v21, 1.0, v21
    v_rcp_f32 v21, v21
    s_nop 0
    v_mul_f32 v37, v37, v21
    v_cvt_pk_bf16_f32 v37, 0, v37
    v_mul_f32 v37, v37, v69
    v_cvt_pk_bf16_f32 v38, 0, v38
    v_cvt_pk_bf16_f32 v70, 0, v70
    v_mul_f32 v21, 0xbfb8aa3b, v38
    v_exp_f32 v21, v21
    s_nop 0
    v_add_f32 v21, 1.0, v21
    v_rcp_f32 v21, v21
    s_nop 0
    v_mul_f32 v38, v38, v21
    v_cvt_pk_bf16_f32 v38, 0, v38
    v_mul_f32 v38, v38, v70
    v_cvt_pk_bf16_f32 v39, 0, v39
    v_cvt_pk_bf16_f32 v71, 0, v71
    v_mul_f32 v21, 0xbfb8aa3b, v39
    v_exp_f32 v21, v21
    s_nop 0
    v_add_f32 v21, 1.0, v21
    v_rcp_f32 v21, v21
    s_nop 0
    v_mul_f32 v39, v39, v21
    v_cvt_pk_bf16_f32 v39, 0, v39
    v_mul_f32 v39, v39, v71
    v_cvt_pk_bf16_f32 v2, v32, v33
    v_cvt_pk_bf16_f32 v3, v34, v35
    v_cvt_pk_bf16_f32 v4, v36, v37
    v_cvt_pk_bf16_f32 v5, v38, v39
    ds_write_b128 v19, v[2:5]
    s_mov_b32 s32, s20
    s_mov_b32 s33, s21
    s_mov_b32 s34, 1409024
    s_mov_b32 s35, 0x20000
    s_lshl_b32 s58, s68, 17
    s_lshl_b32 s59, s69, 8
    s_add_u32 s58, s58, s59
    v_lshl_add_u32 v21, v29, 4, s58
    v_lshl_add_u32 v18, v28, 13, v21
    s_cmp_eq_u32 s68, 10
    s_cselect_b32 s57, 3, 4
    v_mov_b32 v32, 0
    v_mov_b32 v33, 0
    v_mov_b32 v34, 0
    v_mov_b32 v35, 0
    v_mov_b32 v36, 0
    v_mov_b32 v37, 0
    v_mov_b32 v38, 0
    v_mov_b32 v39, 0
    v_mov_b32 v40, 0
    v_mov_b32 v41, 0
    v_mov_b32 v42, 0
    v_mov_b32 v43, 0
    v_mov_b32 v44, 0
    v_mov_b32 v45, 0
    v_mov_b32 v46, 0
    v_mov_b32 v47, 0
    v_mov_b32 v48, 0
    v_mov_b32 v49, 0
    v_mov_b32 v50, 0
    v_mov_b32 v51, 0
    v_mov_b32 v52, 0
    v_mov_b32 v53, 0
    v_mov_b32 v54, 0
    v_mov_b32 v55, 0
    v_mov_b32 v56, 0
    v_mov_b32 v57, 0
    v_mov_b32 v58, 0
    v_mov_b32 v59, 0
    v_mov_b32 v60, 0
    v_mov_b32 v61, 0
    v_mov_b32 v62, 0
    v_mov_b32 v63, 0
L_f2:
    s_waitcnt lgkmcnt(0)
    ds_read_b128 v[2:5], v20
    s_mov_b32 s56, 0
    buffer_load_dwordx4 v[224:227], v18, s[32:35], s56 offen nt
    s_mov_b32 s56, 1024
    buffer_load_dwordx4 v[228:231], v18, s[32:35], s56 offen nt
    s_mov_b32 s56, 2048
    buffer_load_dwordx4 v[232:235], v18, s[32:35], s56 offen nt
    s_mov_b32 s56, 3072
    buffer_load_dwordx4 v[236:239], v18, s[32:35], s56 offen nt
    s_mov_b32 s56, 4096
    buffer_load_dwordx4 v[240:243], v18, s[32:35], s56 offen nt
    s_mov_b32 s56, 5120
    buffer_load_dwordx4 v[244:247], v18, s[32:35], s56 offen nt
    s_mov_b32 s56, 6144
    buffer_load_dwordx4 v[248:251], v18, s[32:35], s56 offen nt
    s_mov_b32 s56, 7168
    buffer_load_dwordx4 v[252:255], v18, s[32:35], s56 offen nt
    v_add_u32 v18, 32768, v18
    v_add_u32 v20, 64, v20
    s_waitcnt vmcnt(0) lgkmcnt(0)
    v_perm_b32 v64, v228, v224, s63
    v_perm_b32 v65, v236, v232, s63
    v_perm_b32 v66, v244, v240, s63
    v_perm_b32 v67, v252, v248, s63
    v_perm_b32 v68, v228, v224, s64
    v_perm_b32 v69, v236, v232, s64
    v_perm_b32 v70, v244, v240, s64
    v_perm_b32 v71, v252, v248, s64
    v_perm_b32 v72, v229, v225, s63
    v_perm_b32 v73, v237, v233, s63
    v_perm_b32 v74, v245, v241, s63
    v_perm_b32 v75, v253, v249, s63
    v_perm_b32 v76, v229, v225, s64
    v_perm_b32 v77, v237, v233, s64
    v_perm_b32 v78, v245, v241, s64
    v_perm_b32 v79, v253, v249, s64
    v_perm_b32 v80, v230, v226, s63
    v_perm_b32 v81, v238, v234, s63
    v_perm_b32 v82, v246, v242, s63
    v_perm_b32 v83, v254, v250, s63
    v_perm_b32 v84, v230, v226, s64
    v_perm_b32 v85, v238, v234, s64
    v_perm_b32 v86, v246, v242, s64
    v_perm_b32 v87, v254, v250, s64
    v_perm_b32 v88, v231, v227, s63
    v_perm_b32 v89, v239, v235, s63
    v_perm_b32 v90, v247, v243, s63
    v_perm_b32 v91, v255, v251, s63
    v_perm_b32 v92, v231, v227, s64
    v_perm_b32 v93, v239, v235, s64
    v_perm_b32 v94, v247, v243, s64
    v_perm_b32 v95, v255, v251, s64
    s_nop 1
    v_mfma_f32_16x16x32_bf16 v[32:35], v[2:5], v[64:67], v[32:35]
    v_mfma_f32_16x16x32_bf16 v[36:39], v[2:5], v[68:71], v[36:39]
    v_mfma_f32_16x16x32_bf16 v[40:43], v[2:5], v[72:75], v[40:43]
    v_mfma_f32_16x16x32_bf16 v[44:47], v[2:5], v[76:79], v[44:47]
    v_mfma_f32_16x16x32_bf16 v[48:51], v[2:5], v[80:83], v[48:51]
    v_mfma_f32_16x16x32_bf16 v[52:55], v[2:5], v[84:87], v[52:55]
    v_mfma_f32_16x16x32_bf16 v[56:59], v[2:5], v[88:91], v[56:59]
    v_mfma_f32_16x16x32_bf16 v[60:63], v[2:5], v[92:95], v[60:63]
    s_sub_u32 s57, s57, 1
    s_cmp_lg_u32 s57, 0
    s_cbranch_scc1 L_f2
L_fout:
    v_lshrrev_b32 v21, 8, v25
    s_mov_b32 s60, 0xffffff00
    s_nop 5
    v_bfi_b32 v8, s60, v32, v25
    v_bfi_b32 v9, s60, v36, v21
    v_mov_b32 v10, v40
    v_mov_b32 v11, v44
    v_bfi_b32 v12, s60, v48, v25
    v_bfi_b32 v13, s60, v52, v21
    v_mov_b32 v14, v56
    v_mov_b32 v15, v60
    buffer_store_dwordx4 v[8:11], v24, s[44:47], 0 offen sc1
    buffer_store_dwordx4 v[12:15], v24, s[44:47], 0 offen offset:1024 sc1
    s_branch L_join
L_end:
    s_endpgm
.section .rodata,"a"
.p2align 6
.amdhsa_kernel gated_mix__mha_block_cached__swiglu_ffn__decode_kernel
  .amdhsa_next_free_vgpr 256
  .amdhsa_next_free_sgpr 96
  .amdhsa_accum_offset 256
  .amdhsa_group_segment_fixed_size 0
  .amdhsa_kernarg_size 104
  .amdhsa_user_sgpr_count 2
  .amdhsa_user_sgpr_kernarg_segment_ptr 1
  .amdhsa_system_sgpr_workgroup_id_x 1
.end_amdhsa_kernel
```
